```python
import torch

def _softmax(x, axis=-1):
    return torch.softmax(x, dim=axis)
def _gelu(x):
    return torch.nn.functional.gelu(x, approximate="tanh")
def _silu(x):
    return torch.nn.functional.silu(x)
def _sigmoid(x):
    return torch.sigmoid(x)
def _layernorm(x, axis=-1, eps=1e-5):
    m = x.mean(dim=axis, keepdim=True)
    v = x.var(dim=axis, keepdim=True, unbiased=False)
    return (x - m) / torch.sqrt(v + eps)
def _scatter_add(tgt, idx, src, axis=0):
    return tgt.clone().index_add_(axis, idx, src)
def _segment_sum(src, seg, n):
    out = torch.zeros((n,) + src.shape[1:], dtype=src.dtype)
    return out.index_add_(0, seg, src)
def _pad(x, pw):
    flat = tuple(v for pair in reversed(pw) for v in pair)
    return torch.nn.functional.pad(x, flat)

kernel_name = 'recurrent_scan__gqa_block_cached__glu_gated_geglu__decode'

def setup_inputs():

    _w = (lambda a: (lambda t: t.to(torch.bfloat16) if t.is_floating_point() else t)(torch.as_tensor(a)))
    def _A_setup():
        B, Sq, D = 1, 1, 512
        Hq, Hkv, Sk, Dh = 32, 8, 32768, 128
        assert Hq % Hkv == 0, (Hq, Hkv)
        return {
            "x": _w((lambda *s: torch.randn(*s, dtype=torch.bfloat16) * 0.4)(B, Sq, D)),
            "k_cache": _w((lambda *s: torch.randn(*s, dtype=torch.bfloat16) * 1.6)(B, Hkv, Sk, Dh)),
            "v_cache": _w((lambda *s: torch.randn(*s, dtype=torch.bfloat16) * 1.6)(B, Hkv, Sk, Dh)),
            "wq": _w((lambda *s: torch.randn(*s, dtype=torch.bfloat16) * 1.6)(D, Hq * Dh) * (D ** -0.5)),
            "wo": _w((lambda *s: torch.randn(*s, dtype=torch.bfloat16) * 1.6)(Hq * Dh, D) * ((Hq * Dh) ** -0.5)),
        }
    _A_in = _A_setup()

    def _B_setup():
        B, S, Dm, Df = 1, 1, 512, 1792
        return {
            "x": _w((lambda *s: torch.randn(*s, dtype=torch.bfloat16) * 0.4)(B, S, Dm)),
            "w_gate": _w((lambda *s: torch.randn(*s, dtype=torch.bfloat16) * 1.6)(Dm, Df) * (Dm ** -0.5)),
            "w_up": _w((lambda *s: torch.randn(*s, dtype=torch.bfloat16) * 1.6)(Dm, Df) * (Dm ** -0.5)),
            "w_down": _w((lambda *s: torch.randn(*s, dtype=torch.bfloat16) * 1.6)(Df, Dm) * (Df ** -0.5)),
        }
    _B_in = _B_setup()

    return {
        "A_x": _A_in["x"],
        "A_k_cache": _A_in["k_cache"],
        "A_v_cache": _A_in["v_cache"],
        "A_wq": _A_in["wq"],
        "A_wo": _A_in["wo"],
        "B_x": _B_in["x"],
        "B_w_gate": _B_in["w_gate"],
        "B_w_up": _B_in["w_up"],
        "B_w_down": _B_in["w_down"],
    }

def reference(A_x, A_k_cache, A_v_cache, A_wq, A_wo, B_x, B_w_gate, B_w_up, B_w_down):
    def _A_ref(x, k_cache, v_cache, wq, wo):
        B, Sq, D = x.shape
        Hq, Dh = 32, 128
        Hkv = k_cache.shape[1]
        rep = Hq // Hkv
        q = (lambda x, *d: x.permute(*d))((x @ wq).reshape(B, Sq, Hq, Dh), 0, 2, 1, 3)
        k = (lambda x, n, axis: torch.repeat_interleave(x, n, dim=axis))(k_cache, rep, axis=1)
        v = (lambda x, n, axis: torch.repeat_interleave(x, n, dim=axis))(v_cache, rep, axis=1)
        scores = torch.einsum("bhqd,bhkd->bhqk", q, k) * (Dh ** -0.5)
        p = _softmax(scores, axis=-1)
        o = torch.einsum("bhqk,bhkd->bhqd", p, v)
        return (lambda x, *d: x.permute(*d))(o, 0, 2, 1, 3).reshape(B, Sq, Hq * Dh) @ wo

    def _B_ref(x, w_gate, w_up, w_down):
        g = torch.einsum("bsd,df->bsf", x, w_gate)
        u = torch.einsum("bsd,df->bsf", x, w_up)
        h = _gelu(g) * u
        return torch.einsum("bsf,fd->bsd", h, w_down)

    x = A_x
    xn = _layernorm(x, axis=-1)
    s = _A_ref(xn, A_k_cache, A_v_cache, A_wq, A_wo)
    g = _silu(_B_ref(xn, B_w_gate, B_w_up, B_w_down))
    return x + s * g
```

```asm
; @launch grid=(256,1,1) block=(512,1,1) lds=24576
.amdgcn_target "amdgcn-amd-amdhsa--gfx950"
.text
.globl recurrent_scan__gqa_block_cached__glu_gated_geglu__decode_kernel
.p2align 8
.type recurrent_scan__gqa_block_cached__glu_gated_geglu__decode_kernel,@function
recurrent_scan__gqa_block_cached__glu_gated_geglu__decode_kernel:
    s_cmp_ge_u32 s2, 256
    s_cbranch_scc1 L_end
    s_mov_b32 s100, s2
    s_load_dwordx16 s[36:51], s[0:1], 0
    s_load_dwordx8 s[52:59], s[0:1], 64
    v_lshrrev_b32 v4, 6, v0
    v_and_b32 v1, 63, v0
    v_readfirstlane_b32 s3, v4
    s_lshr_b32 s4, s2, 5
    s_and_b32 s5, s2, 31
    v_lshlrev_b32 v3, 4, v1
    v_bfe_u32 v4, v1, 2, 2
    v_lshlrev_b32 v2, 8, v4
    v_lshrrev_b32 v4, 4, v1
    v_lshl_add_u32 v2, v4, 6, v2
    v_and_b32 v5, 3, v1
    v_lshl_add_u32 v2, v5, 4, v2
    v_lshrrev_b32 v56, 3, v0
    v_and_b32 v58, 7, v0
    v_lshlrev_b32 v58, 4, v58
    v_mul_u32_u24 v60, 3584, v56
    v_add_u32 v60, v60, v58
    s_and_b32 s69, s5, 3
    v_lshl_add_u32 v57, v56, 13, v58
    v_add_u32 v58, 0x80000, v57
    s_lshl_b32 s68, s69, 20
    s_lshl_b32 s7, s4, 10
    s_add_u32 s68, s68, s7
    s_lshr_b32 s7, s5, 2
    s_lshl_b32 s7, s7, 7
    s_add_u32 s68, s68, s7
    s_mul_i32 s70, s5, 229376
    s_lshl_b32 s7, s3, 12
    s_add_u32 s70, s70, s7
    s_lshl_b32 s99, s4, 23
    s_add_u32 s70, s70, s99
    s_waitcnt lgkmcnt(0)
    s_mov_b32 s8, s36
    s_and_b32 s9, s37, 0xffff
    s_mov_b32 s10, 1024
    s_mov_b32 s11, 0x20000
    buffer_load_dwordx4 v[52:55], v3, s[8:11], 0 offen
    s_mov_b32 s20, s42
    s_and_b32 s21, s43, 0xffff
    s_mov_b32 s22, 4194304
    s_mov_b32 s23, 0x20000
    buffer_load_dwordx4 v[20:23], v57, s[20:23], s68 offen nt
    buffer_load_dwordx4 v[24:27], v58, s[20:23], s68 offen nt
    s_mov_b32 s12, s38
    s_and_b32 s13, s39, 0xffff
    s_mov_b32 s14, 67108864
    s_mov_b32 s15, 0x20000
    s_mov_b32 s16, s40
    s_and_b32 s17, s41, 0xffff
    s_mov_b32 s18, 67108864
    s_mov_b32 s19, 0x20000
    s_mov_b32 s24, s44
    s_and_b32 s25, s45, 0xffff
    s_mov_b32 s26, 4194304
    s_mov_b32 s27, 0x20000
    s_load_dword s6, s[58:59], 0
    s_mul_i32 s96, s4, 7
    s_lshr_b32 s7, s5, 2
    s_add_u32 s96, s96, s7
    s_cmp_ge_u32 s96, 28
    s_cselect_b32 s28, s50, s48
    s_cselect_b32 s29, s51, s49
    s_cselect_b32 s7, 28, 0
    s_and_b32 s29, s29, 0xffff
    s_mov_b32 s30, 1835008
    s_mov_b32 s31, 0x20000
    s_sub_u32 s97, s96, s7
    s_lshl_b32 s97, s97, 7
    s_mul_i32 s7, s69, 458752
    s_add_u32 s97, s97, s7
    s_lshl_b32 s96, s96, 11
    s_lshl_b32 s7, s69, 9
    s_add_u32 s96, s96, s7
    s_add_u32 s96, s96, 393216
    s_cmp_lt_u32 s5, 28
    s_cselect_b32 s97, s97, 1073741824
    s_cselect_b32 s96, s96, 1073741824
    s_add_u32 s40, s70, 0
    s_add_u32 s41, s70, 32768
    s_add_u32 s42, s70, 65536
    s_add_u32 s43, s70, 98304
    s_add_u32 s44, s70, 131072
    s_add_u32 s45, s70, 163840
    s_add_u32 s46, s70, 196608
    buffer_load_dwordx4 v[64:67], v2, s[12:15], s40 offen offset:0 nt
    buffer_load_dwordx4 v[68:71], v2, s[12:15], s40 offen offset:1024 nt
    s_mov_b32 s64, s58
    s_and_b32 s65, s59, 0xffff
    s_mov_b32 s66, 268435456
    s_mov_b32 s67, 0x20000
    s_mov_b32 s32, s52
    s_and_b32 s33, s53, 0xffff
    s_mov_b32 s34, 1835008
    s_mov_b32 s35, 0x20000
    s_mov_b32 s60, s54
    s_and_b32 s61, s55, 0xffff
    s_mov_b32 s62, 1024
    s_mov_b32 s63, 0x20000
    s_lshl_b32 s53, s4, 3
    s_add_u32 s53, s53, s3
    s_lshl_b32 s53, s53, 8
    s_add_u32 s53, s53, 32768
    s_cmp_eq_u32 s5, 0
    s_cselect_b32 s7, s53, 1073741824
    v_mov_b32 v4, 0
    v_mov_b32 v5, 0
    v_mov_b32 v6, 0
    v_mov_b32 v7, 0
    v_mov_b32 v8, 6144
    s_mov_b64 exec, 1
    buffer_store_dword v4, v4, s[64:67], s7 offen sc1
    s_mov_b64 exec, -1
    buffer_load_dwordx4 v[72:75], v2, s[12:15], s40 offen offset:2048 nt
    buffer_load_dwordx4 v[76:79], v2, s[12:15], s40 offen offset:3072 nt
    buffer_load_dwordx4 v[80:83], v2, s[12:15], s41 offen offset:0 nt
    buffer_load_dwordx4 v[84:87], v2, s[12:15], s41 offen offset:1024 nt
    buffer_load_dwordx4 v[88:91], v2, s[12:15], s41 offen offset:2048 nt
    buffer_load_dwordx4 v[92:95], v2, s[12:15], s41 offen offset:3072 nt
    s_mul_i32 s52, s3, 131072
    s_add_u32 s52, s52, s99
    s_add_u32 s52, s52, 7340032
    s_mov_b32 s99, 1035273459
    s_mov_b32 s56, 0
    s_mov_b32 s57, 0
    ds_write_b128 v8, v[4:7]
    ds_write_b32 v8, v4 offset:16
    v_and_b32 v63, 3, v1
    v_mov_b32 v9, 0x0c0c0c0c
    v_mov_b32 v10, 0x0c0c0c0c
    v_mov_b32 v11, 0x0c0c0c0c
    v_mov_b32 v59, 0x0c0c0100
    v_mov_b32 v12, 0x01000c0c
    v_mov_b32 v61, 0x0c0c0302
    v_mov_b32 v62, 0x03020c0c
    s_waitcnt lgkmcnt(0)
    s_barrier
    v_mov_b32 v8, 0x0c0c0c0c
    v_cmp_eq_u32 vcc, 0, v63
    s_nop 1
    v_cndmask_b32 v8, v8, v59, vcc
    v_cndmask_b32 v10, v10, v61, vcc
    v_cmp_eq_u32 vcc, 1, v63
    s_nop 1
    v_cndmask_b32 v8, v8, v12, vcc
    v_cndmask_b32 v10, v10, v62, vcc
    v_cmp_eq_u32 vcc, 2, v63
    s_nop 1
    v_cndmask_b32 v9, v9, v59, vcc
    v_cndmask_b32 v11, v11, v61, vcc
    v_cmp_eq_u32 vcc, 3, v63
    s_nop 1
    v_cndmask_b32 v9, v9, v12, vcc
    v_cndmask_b32 v11, v11, v62, vcc
    s_add_u32 s6, s6, 2654435761
    v_mov_b32 v62, 0x05040100
    v_mov_b32 v63, 0x07060302
    s_waitcnt vmcnt(11)
    v_lshlrev_b32 v224, 16, v52
    v_and_b32 v225, 0xffff0000, v52
    v_lshlrev_b32 v226, 16, v53
    v_and_b32 v227, 0xffff0000, v53
    v_lshlrev_b32 v228, 16, v54
    v_and_b32 v229, 0xffff0000, v54
    v_lshlrev_b32 v230, 16, v55
    v_and_b32 v231, 0xffff0000, v55
    v_add_f32 v232, v224, v225
    v_add_f32 v233, v226, v227
    v_add_f32 v234, v228, v229
    v_add_f32 v235, v230, v231
    v_add_f32 v232, v232, v233
    v_add_f32 v234, v234, v235
    v_add_f32 v232, v232, v234
    s_nop 1
    v_add_f32 v232, v232, v232 quad_perm:[1,0,3,2] row_mask:0xf bank_mask:0xf
    s_nop 1
    v_add_f32 v232, v232, v232 quad_perm:[2,3,0,1] row_mask:0xf bank_mask:0xf
    s_nop 1
    v_add_f32 v232, v232, v232 row_ror:4 row_mask:0xf bank_mask:0xf
    s_nop 1
    v_add_f32 v232, v232, v232 row_ror:8 row_mask:0xf bank_mask:0xf
    v_mov_b32 v234, v232
    s_nop 1
    v_permlane16_swap_b32 v232, v234
    v_add_f32 v232, v232, v234
    v_mov_b32 v234, v232
    s_nop 1
    v_permlane32_swap_b32 v232, v234
    v_add_f32 v232, v232, v234
    v_mul_f32 v235, 0x3b000000, v232
    v_sub_f32 v236, v224, v235
    v_sub_f32 v237, v225, v235
    v_sub_f32 v238, v226, v235
    v_sub_f32 v239, v227, v235
    v_sub_f32 v240, v228, v235
    v_sub_f32 v241, v229, v235
    v_sub_f32 v242, v230, v235
    v_sub_f32 v243, v231, v235
    v_mul_f32 v232, v236, v236
    v_mul_f32 v233, v237, v237
    v_fmac_f32 v232, v238, v238
    v_fmac_f32 v233, v239, v239
    v_fmac_f32 v232, v240, v240
    v_fmac_f32 v233, v241, v241
    v_fmac_f32 v232, v242, v242
    v_fmac_f32 v233, v243, v243
    v_add_f32 v232, v232, v233
    s_nop 1
    v_add_f32 v232, v232, v232 quad_perm:[1,0,3,2] row_mask:0xf bank_mask:0xf
    s_nop 1
    v_add_f32 v232, v232, v232 quad_perm:[2,3,0,1] row_mask:0xf bank_mask:0xf
    s_nop 1
    v_add_f32 v232, v232, v232 row_ror:4 row_mask:0xf bank_mask:0xf
    s_nop 1
    v_add_f32 v232, v232, v232 row_ror:8 row_mask:0xf bank_mask:0xf
    v_mov_b32 v234, v232
    s_nop 1
    v_permlane16_swap_b32 v232, v234
    v_add_f32 v232, v232, v234
    v_mov_b32 v234, v232
    s_nop 1
    v_permlane32_swap_b32 v232, v234
    v_add_f32 v232, v232, v234
    v_mul_f32 v232, 0x3b000000, v232
    v_cvt_pk_bf16_f32 v232, v232, v232
    v_and_b32 v232, 0xffff0000, v232
    v_add_f32 v232, 0x3727c5ac, v232
    v_cvt_pk_bf16_f32 v232, v232, v232
    v_and_b32 v232, 0xffff0000, v232
    v_sqrt_f32 v232, v232
    s_nop 0
    v_cvt_pk_bf16_f32 v232, v232, v232
    v_and_b32 v232, 0xffff0000, v232
    v_cvt_pk_bf16_f32 v235, v235, v235
    v_and_b32 v235, 0xffff0000, v235
    v_rcp_f32 v233, v232
    v_sub_f32 v236, v224, v235
    v_sub_f32 v237, v225, v235
    v_sub_f32 v238, v226, v235
    v_sub_f32 v239, v227, v235
    v_sub_f32 v240, v228, v235
    v_sub_f32 v241, v229, v235
    v_sub_f32 v242, v230, v235
    v_sub_f32 v243, v231, v235
    v_cvt_pk_bf16_f32 v234, v236, v237
    v_lshlrev_b32 v236, 16, v234
    v_and_b32 v237, 0xffff0000, v234
    v_cvt_pk_bf16_f32 v234, v238, v239
    v_lshlrev_b32 v238, 16, v234
    v_and_b32 v239, 0xffff0000, v234
    v_cvt_pk_bf16_f32 v234, v240, v241
    v_lshlrev_b32 v240, 16, v234
    v_and_b32 v241, 0xffff0000, v234
    v_cvt_pk_bf16_f32 v234, v242, v243
    v_lshlrev_b32 v242, 16, v234
    v_and_b32 v243, 0xffff0000, v234
    v_mul_f32 v224, v236, v233
    v_fma_f32 v236, -v224, v232, v236
    v_fmac_f32 v224, v236, v233
    v_mul_f32 v225, v237, v233
    v_fma_f32 v237, -v225, v232, v237
    v_fmac_f32 v225, v237, v233
    v_mul_f32 v226, v238, v233
    v_fma_f32 v238, -v226, v232, v238
    v_fmac_f32 v226, v238, v233
    v_mul_f32 v227, v239, v233
    v_fma_f32 v239, -v227, v232, v239
    v_fmac_f32 v227, v239, v233
    v_mul_f32 v228, v240, v233
    v_fma_f32 v240, -v228, v232, v240
    v_fmac_f32 v228, v240, v233
    v_mul_f32 v229, v241, v233
    v_fma_f32 v241, -v229, v232, v241
    v_fmac_f32 v229, v241, v233
    v_mul_f32 v230, v242, v233
    v_fma_f32 v242, -v230, v232, v242
    v_fmac_f32 v230, v242, v233
    v_mul_f32 v231, v243, v233
    v_fma_f32 v243, -v231, v232, v243
    v_fmac_f32 v231, v243, v233
    v_cvt_pk_bf16_f32 v234, v224, v225
    v_lshlrev_b32 v224, 16, v234
    v_and_b32 v225, 0xffff0000, v234
    v_cvt_pk_bf16_f32 v234, v226, v227
    v_lshlrev_b32 v226, 16, v234
    v_and_b32 v227, 0xffff0000, v234
    v_cvt_pk_bf16_f32 v234, v228, v229
    v_lshlrev_b32 v228, 16, v234
    v_and_b32 v229, 0xffff0000, v234
    v_cvt_pk_bf16_f32 v234, v230, v231
    v_lshlrev_b32 v230, 16, v234
    v_and_b32 v231, 0xffff0000, v234
    v_lshlrev_b32 v234, 5, v1
    ds_write_b128 v234, v[224:227] offset:0
    ds_write_b128 v234, v[228:231] offset:16
    v_lshlrev_b32 v56, 2, v56
    s_lshl_b32 s7, s69, 9
    v_add_u32 v56, s7, v56
    ds_read_b32 v244, v56 offset:0
    ds_read_b32 v245, v56 offset:256
    v_bfe_u32 v234, v1, 4, 1
    v_lshrrev_b32 v232, 5, v1
    v_lshl_add_u32 v234, v234, 1, v232
    v_and_b32 v232, 7, v1
    v_lshl_add_u32 v234, v232, 3, v234
    v_lshlrev_b32 v59, 2, v234
    s_lshl_b32 s7, s3, 8
    v_add_u32 v59, s7, v59
    s_lshl_b32 s71, s4, 14
    s_add_u32 s71, s71, 131072
    s_lshl_b32 s7, s5, 9
    s_add_u32 s68, s71, s7
    s_lshl_b32 s7, s3, 11
    s_add_u32 s70, s71, s7
    s_mov_b32 s71, 1
    s_mov_b32 s101, s6
    s_waitcnt vmcnt(6) lgkmcnt(0)
    v_perm_b32 v61, v245, v244, v63
    v_perm_b32 v44, v24, v20, v62
    v_perm_b32 v45, v24, v20, v63
    v_perm_b32 v46, v25, v21, v62
    v_perm_b32 v47, v25, v21, v63
    v_perm_b32 v48, v26, v22, v62
    v_perm_b32 v49, v26, v22, v63
    v_perm_b32 v50, v27, v23, v62
    v_perm_b32 v51, v27, v23, v63
    v_dot2_f32_bf16 v36, v44, v61, 0
    v_dot2_f32_bf16 v37, v45, v61, 0
    v_dot2_f32_bf16 v38, v46, v61, 0
    v_dot2_f32_bf16 v39, v47, v61, 0
    v_dot2_f32_bf16 v40, v48, v61, 0
    v_dot2_f32_bf16 v41, v49, v61, 0
    v_dot2_f32_bf16 v42, v50, v61, 0
    v_dot2_f32_bf16 v43, v51, v61, 0
    v_permlane32_swap_b32 v36, v37
    v_permlane32_swap_b32 v38, v39
    v_permlane32_swap_b32 v40, v41
    v_permlane32_swap_b32 v42, v43
    v_add_f32 v36, v36, v37
    v_add_f32 v38, v38, v39
    v_add_f32 v40, v40, v41
    v_add_f32 v42, v42, v43
    v_permlane16_swap_b32 v36, v38
    s_nop 0
    v_permlane16_swap_b32 v40, v42
    v_add_f32 v36, v36, v38
    v_add_f32 v40, v40, v42
    s_nop 0
    v_add_f32 v36, v36, v36 row_ror:8 row_mask:0xf bank_mask:0xf
    v_add_f32 v40, v40, v40 row_ror:8 row_mask:0xf bank_mask:0xf
    ds_write_b32 v59, v36 offset:2048
    ds_write_b32 v59, v40 offset:2064
    v_mov_b32 v44, 6144
    v_mov_b32 v45, 1
    s_mov_b64 exec, 1
    ds_add_rtn_u32 v46, v44, v45
    s_mov_b64 exec, -1
    buffer_load_dwordx4 v[96:99], v2, s[12:15], s42 offen offset:0 nt
    s_waitcnt lgkmcnt(0)
    v_readfirstlane_b32 s7, v46
    s_nop 0
    s_cmp_eq_u32 s7, 7
    s_nop 2
    s_cbranch_scc0 L_tk_1
    v_and_b32 v44, 31, v1
    v_lshlrev_b32 v45, 3, v44
    v_lshlrev_b32 v44, 4, v44
    v_lshrrev_b32 v46, 5, v1
    v_lshl_add_u32 v45, v46, 10, v45
    ds_read_b64 v[36:37], v45 offset:2048
    ds_read_b64 v[38:39], v45 offset:2304
    ds_read_b64 v[40:41], v45 offset:2560
    ds_read_b64 v[42:43], v45 offset:2816
    v_mov_b32 v50, s6
    v_mov_b32 v51, s6
    s_waitcnt lgkmcnt(0)
    v_pk_add_f32 v[36:37], v[36:37], v[38:39]
    v_pk_add_f32 v[40:41], v[40:41], v[42:43]
    v_pk_add_f32 v[48:49], v[36:37], v[40:41]
    v_mov_b32 v40, v48
    v_mov_b32 v41, v49
    s_nop 0
    v_permlane32_swap_b32 v48, v40
    v_permlane32_swap_b32 v49, v41
    v_add_f32 v48, v48, v40
    v_add_f32 v49, v49, v41
    s_mov_b32 exec_hi, 0
    buffer_store_dwordx4 v[48:51], v44, s[64:67], s68 offen sc1
    s_mov_b64 exec, -1
    s_nop 0
L_tk_1:
    buffer_load_dwordx4 v[100:103], v2, s[12:15], s42 offen offset:1024 nt
    s_waitcnt vmcnt(7)
    buffer_load_dwordx4 v[104:107], v2, s[12:15], s42 offen offset:2048 nt
    s_waitcnt vmcnt(7)
    buffer_load_dwordx4 v[108:111], v2, s[12:15], s42 offen offset:3072 nt
    s_waitcnt vmcnt(7)
    buffer_load_dwordx4 v[112:115], v2, s[12:15], s43 offen offset:0 nt
    v_add_u32 v58, 229376, v60
    buffer_load_dwordx4 v[20:23], v60, s[28:31], s97 offen nt
    buffer_load_dwordx4 v[24:27], v58, s[28:31], s97 offen nt
    s_waitcnt vmcnt(9)
    buffer_load_dwordx4 v[116:119], v2, s[12:15], s43 offen offset:1024 nt
    s_waitcnt vmcnt(9)
    buffer_load_dwordx4 v[120:123], v2, s[12:15], s43 offen offset:2048 nt
    s_waitcnt vmcnt(9)
    buffer_load_dwordx4 v[124:127], v2, s[12:15], s43 offen offset:3072 nt
    s_waitcnt vmcnt(9)
    buffer_load_dwordx4 v[128:131], v2, s[12:15], s44 offen offset:0 nt
    s_waitcnt vmcnt(9)
    buffer_load_dwordx4 v[132:135], v2, s[12:15], s44 offen offset:1024 nt
    s_waitcnt vmcnt(9)
    buffer_load_dwordx4 v[136:139], v2, s[12:15], s44 offen offset:2048 nt
    s_waitcnt vmcnt(9)
    buffer_load_dwordx4 v[140:143], v2, s[12:15], s44 offen offset:3072 nt
    s_waitcnt vmcnt(9)
    buffer_load_dwordx4 v[144:147], v2, s[12:15], s45 offen offset:0 nt
    s_waitcnt vmcnt(7)
    buffer_load_dwordx4 v[148:151], v2, s[12:15], s45 offen offset:1024 nt
    v_perm_b32 v44, v24, v20, v62
    v_perm_b32 v45, v24, v20, v63
    v_perm_b32 v46, v25, v21, v62
    v_perm_b32 v47, v25, v21, v63
    v_perm_b32 v48, v26, v22, v62
    v_perm_b32 v49, v26, v22, v63
    v_perm_b32 v50, v27, v23, v62
    v_perm_b32 v51, v27, v23, v63
    v_dot2_f32_bf16 v36, v44, v61, 0
    v_dot2_f32_bf16 v37, v45, v61, 0
    v_dot2_f32_bf16 v38, v46, v61, 0
    v_dot2_f32_bf16 v39, v47, v61, 0
    v_dot2_f32_bf16 v40, v48, v61, 0
    v_dot2_f32_bf16 v41, v49, v61, 0
    v_dot2_f32_bf16 v42, v50, v61, 0
    v_dot2_f32_bf16 v43, v51, v61, 0
    v_permlane32_swap_b32 v36, v37
    v_permlane32_swap_b32 v38, v39
    v_permlane32_swap_b32 v40, v41
    v_permlane32_swap_b32 v42, v43
    v_add_f32 v36, v36, v37
    v_add_f32 v38, v38, v39
    v_add_f32 v40, v40, v41
    v_add_f32 v42, v42, v43
    v_permlane16_swap_b32 v36, v38
    s_nop 0
    v_permlane16_swap_b32 v40, v42
    v_add_f32 v36, v36, v38
    v_add_f32 v40, v40, v42
    s_nop 0
    v_add_f32 v36, v36, v36 row_ror:8 row_mask:0xf bank_mask:0xf
    v_add_f32 v40, v40, v40 row_ror:8 row_mask:0xf bank_mask:0xf
    ds_write_b32 v59, v36 offset:4096
    ds_write_b32 v59, v40 offset:4112
    v_mov_b32 v44, 6156
    v_mov_b32 v45, 1
    s_mov_b64 exec, 1
    ds_add_rtn_u32 v46, v44, v45
    s_mov_b64 exec, -1
    s_waitcnt lgkmcnt(0)
    v_readfirstlane_b32 s7, v46
    s_nop 0
    s_cmp_eq_u32 s7, 7
    s_nop 2
    s_cbranch_scc0 L_tk_2
    v_and_b32 v44, 31, v1
    v_lshlrev_b32 v45, 3, v44
    v_lshlrev_b32 v44, 4, v44
    v_lshrrev_b32 v46, 5, v1
    v_lshl_add_u32 v45, v46, 10, v45
    ds_read_b64 v[36:37], v45 offset:4096
    ds_read_b64 v[38:39], v45 offset:4352
    ds_read_b64 v[40:41], v45 offset:4608
    ds_read_b64 v[42:43], v45 offset:4864
    v_mov_b32 v50, s6
    v_mov_b32 v51, s6
    s_waitcnt lgkmcnt(0)
    v_pk_add_f32 v[36:37], v[36:37], v[38:39]
    v_pk_add_f32 v[40:41], v[40:41], v[42:43]
    v_pk_add_f32 v[48:49], v[36:37], v[40:41]
    v_mov_b32 v40, v48
    v_mov_b32 v41, v49
    s_nop 0
    v_permlane32_swap_b32 v48, v40
    v_permlane32_swap_b32 v49, v41
    v_add_f32 v48, v48, v40
    v_add_f32 v49, v49, v41
    s_mov_b32 exec_hi, 0
    buffer_store_dwordx4 v[48:51], v44, s[64:67], s96 offen sc1
    s_mov_b64 exec, -1
    s_nop 0
L_tk_2:
    s_waitcnt vmcnt(7)
    buffer_load_dwordx4 v[152:155], v2, s[12:15], s45 offen offset:2048 nt
    s_waitcnt vmcnt(7)
    buffer_load_dwordx4 v[156:159], v2, s[12:15], s45 offen offset:3072 nt
    s_waitcnt vmcnt(7)
    buffer_load_dwordx4 v[160:163], v2, s[12:15], s46 offen offset:0 nt
    s_waitcnt vmcnt(7)
    buffer_load_dwordx4 v[164:167], v2, s[12:15], s46 offen offset:1024 nt
    s_waitcnt vmcnt(7)
    buffer_load_dwordx4 v[168:171], v2, s[12:15], s46 offen offset:2048 nt
    s_waitcnt vmcnt(7)
    buffer_load_dwordx4 v[172:175], v2, s[12:15], s46 offen offset:3072 nt
    s_waitcnt vmcnt(7)
    buffer_load_dwordx4 v[176:179], v3, s[16:19], s40 offen offset:0 nt
    s_waitcnt vmcnt(7)
    buffer_load_dwordx4 v[180:183], v3, s[16:19], s40 offen offset:1024 nt
    s_waitcnt vmcnt(7)
    buffer_load_dwordx4 v[184:187], v3, s[16:19], s40 offen offset:2048 nt
    s_waitcnt vmcnt(7)
    buffer_load_dwordx4 v[188:191], v3, s[16:19], s40 offen offset:3072 nt
    buffer_load_dwordx4 v[28:31], v3, s[64:67], s70 offen offset:0 sc1
    buffer_load_dwordx4 v[32:35], v3, s[64:67], s70 offen offset:1024 sc1
    s_waitcnt vmcnt(9)
    buffer_load_dwordx4 v[192:195], v3, s[16:19], s41 offen offset:0 nt
    s_waitcnt vmcnt(9)
    buffer_load_dwordx4 v[196:199], v3, s[16:19], s41 offen offset:1024 nt
    s_waitcnt vmcnt(9)
    buffer_load_dwordx4 v[200:203], v3, s[16:19], s41 offen offset:2048 nt
    s_waitcnt vmcnt(9)
    buffer_load_dwordx4 v[204:207], v3, s[16:19], s41 offen offset:3072 nt
    s_waitcnt vmcnt(9)
    buffer_load_dwordx4 v[208:211], v3, s[16:19], s42 offen offset:0 nt
    s_waitcnt vmcnt(9)
    buffer_load_dwordx4 v[212:215], v3, s[16:19], s42 offen offset:1024 nt
    s_waitcnt vmcnt(9)
    buffer_load_dwordx4 v[216:219], v3, s[16:19], s42 offen offset:2048 nt
    s_waitcnt vmcnt(9)
    buffer_load_dwordx4 v[220:223], v3, s[16:19], s42 offen offset:3072 nt
    s_waitcnt vmcnt(7)
    buffer_load_dwordx4 v[224:227], v3, s[16:19], s43 offen offset:0 nt
    s_cmp_eq_u32 s71, 0
    s_cbranch_scc1 L_pl_3
    s_mov_b32 s49, 400000
L_pll_4:
    v_xor_b32 v44, s6, v31
    v_xor_b32 v45, s6, v35
    v_or_b32 v44, v44, v45
    v_cmp_ne_u32 vcc, 0, v44
    s_sub_u32 s49, s49, 1
    s_cbranch_scc1 L_plk_5
    s_nop 2
    s_cbranch_vccz L_plk_5
    s_sleep 2
    buffer_load_dwordx4 v[28:31], v3, s[64:67], s70 offen offset:0 sc1
    buffer_load_dwordx4 v[32:35], v3, s[64:67], s70 offen offset:1024 sc1
    s_waitcnt vmcnt(0)
    s_branch L_pll_4
L_plk_5:
    v_pk_add_f32 v[28:29], v[28:29], v[32:33]
    v_mov_b32 v44, v28
    v_mov_b32 v45, v29
    s_nop 0
    v_permlane32_swap_b32 v28, v44
    v_permlane32_swap_b32 v29, v45
    v_add_f32 v28, v28, v44
    v_add_f32 v29, v29, v45
    v_cvt_pk_bf16_f32 v28, v28, v29
    v_and_b32 v46, 31, v1
    v_lshlrev_b32 v46, 2, v46
    s_lshl_b32 s7, s3, 7
    v_add_u32 v46, s7, v46
    ds_write_b32 v46, v28 offset:7168
    v_mov_b32 v44, 6148
    v_mov_b32 v45, 1
    s_mov_b64 exec, 1
    ds_add_u32 v44, v45
    s_mov_b64 exec, -1
    s_mov_b32 s71, 0
    s_mov_b32 s70, 1073741824
L_pl_3:
    v_mov_b32 v45, 6148
    s_mov_b32 s49, 3200000
    s_nop 0
L_sp_6:
    ds_read_b32 v46, v45
    s_waitcnt lgkmcnt(0)
    v_readfirstlane_b32 s7, v46
    s_sub_u32 s49, s49, 1
    s_cbranch_scc1 L_spd_7
    s_cmp_eq_u32 s7, 8
    s_cbranch_scc1 L_spd_7
    s_sleep 1
    s_branch L_sp_6
L_spd_7:
    ds_read_b128 v[4:7], v2 offset:7168
    v_mov_b32 v52, 0xff800000
    s_waitcnt lgkmcnt(0)
    v_mfma_f32_16x16x32_bf16 v[36:39], v[64:67], v[4:7], 0
    v_mfma_f32_16x16x32_bf16 v[40:43], v[68:71], v[4:7], 0
    v_mfma_f32_16x16x32_bf16 v[44:47], v[72:75], v[4:7], 0
    v_mfma_f32_16x16x32_bf16 v[48:51], v[76:79], v[4:7], 0
    s_nop 4
    v_mov_b32 v54, v36 quad_perm:[0,0,0,0] row_mask:0xf bank_mask:0xf
    v_add_f32 v54, v37, v54 quad_perm:[1,1,1,1] row_mask:0xf bank_mask:0xf
    v_add_f32 v54, v38, v54 quad_perm:[2,2,2,2] row_mask:0xf bank_mask:0xf
    v_add_f32 v54, v39, v54 quad_perm:[3,3,3,3] row_mask:0xf bank_mask:0xf
    v_mov_b32 v55, v40 quad_perm:[0,0,0,0] row_mask:0xf bank_mask:0xf
    v_add_f32 v55, v41, v55 quad_perm:[1,1,1,1] row_mask:0xf bank_mask:0xf
    v_add_f32 v55, v42, v55 quad_perm:[2,2,2,2] row_mask:0xf bank_mask:0xf
    v_add_f32 v55, v43, v55 quad_perm:[3,3,3,3] row_mask:0xf bank_mask:0xf
    v_cvt_pk_bf16_f32 v56, v54, v55
    v_lshlrev_b32 v54, 16, v56
    v_and_b32 v55, 0xffff0000, v56
    v_mul_f32 v54, s99, v54
    v_mul_f32 v55, s99, v55
    v_cvt_pk_bf16_f32 v20, v54, v55
    v_max3_f32 v52, v52, v54, v55
    v_mov_b32 v54, v44 quad_perm:[0,0,0,0] row_mask:0xf bank_mask:0xf
    v_add_f32 v54, v45, v54 quad_perm:[1,1,1,1] row_mask:0xf bank_mask:0xf
    v_add_f32 v54, v46, v54 quad_perm:[2,2,2,2] row_mask:0xf bank_mask:0xf
    v_add_f32 v54, v47, v54 quad_perm:[3,3,3,3] row_mask:0xf bank_mask:0xf
    v_mov_b32 v55, v48 quad_perm:[0,0,0,0] row_mask:0xf bank_mask:0xf
    v_add_f32 v55, v49, v55 quad_perm:[1,1,1,1] row_mask:0xf bank_mask:0xf
    v_add_f32 v55, v50, v55 quad_perm:[2,2,2,2] row_mask:0xf bank_mask:0xf
    v_add_f32 v55, v51, v55 quad_perm:[3,3,3,3] row_mask:0xf bank_mask:0xf
    v_cvt_pk_bf16_f32 v56, v54, v55
    v_lshlrev_b32 v54, 16, v56
    v_and_b32 v55, 0xffff0000, v56
    v_mul_f32 v54, s99, v54
    v_mul_f32 v55, s99, v55
    v_cvt_pk_bf16_f32 v21, v54, v55
    v_max3_f32 v52, v52, v54, v55
    s_waitcnt vmcnt(7)
    buffer_load_dwordx4 v[228:231], v3, s[16:19], s43 offen offset:1024 nt
    v_mfma_f32_16x16x32_bf16 v[36:39], v[80:83], v[4:7], 0
    v_mfma_f32_16x16x32_bf16 v[40:43], v[84:87], v[4:7], 0
    v_mfma_f32_16x16x32_bf16 v[44:47], v[88:91], v[4:7], 0
    v_mfma_f32_16x16x32_bf16 v[48:51], v[92:95], v[4:7], 0
    s_nop 4
    v_mov_b32 v54, v36 quad_perm:[0,0,0,0] row_mask:0xf bank_mask:0xf
    v_add_f32 v54, v37, v54 quad_perm:[1,1,1,1] row_mask:0xf bank_mask:0xf
    v_add_f32 v54, v38, v54 quad_perm:[2,2,2,2] row_mask:0xf bank_mask:0xf
    v_add_f32 v54, v39, v54 quad_perm:[3,3,3,3] row_mask:0xf bank_mask:0xf
    v_mov_b32 v55, v40 quad_perm:[0,0,0,0] row_mask:0xf bank_mask:0xf
    v_add_f32 v55, v41, v55 quad_perm:[1,1,1,1] row_mask:0xf bank_mask:0xf
    v_add_f32 v55, v42, v55 quad_perm:[2,2,2,2] row_mask:0xf bank_mask:0xf
    v_add_f32 v55, v43, v55 quad_perm:[3,3,3,3] row_mask:0xf bank_mask:0xf
    v_cvt_pk_bf16_f32 v56, v54, v55
    v_lshlrev_b32 v54, 16, v56
    v_and_b32 v55, 0xffff0000, v56
    v_mul_f32 v54, s99, v54
    v_mul_f32 v55, s99, v55
    v_cvt_pk_bf16_f32 v22, v54, v55
    v_max3_f32 v52, v52, v54, v55
    v_mov_b32 v54, v44 quad_perm:[0,0,0,0] row_mask:0xf bank_mask:0xf
    v_add_f32 v54, v45, v54 quad_perm:[1,1,1,1] row_mask:0xf bank_mask:0xf
    v_add_f32 v54, v46, v54 quad_perm:[2,2,2,2] row_mask:0xf bank_mask:0xf
    v_add_f32 v54, v47, v54 quad_perm:[3,3,3,3] row_mask:0xf bank_mask:0xf
    v_mov_b32 v55, v48 quad_perm:[0,0,0,0] row_mask:0xf bank_mask:0xf
    v_add_f32 v55, v49, v55 quad_perm:[1,1,1,1] row_mask:0xf bank_mask:0xf
    v_add_f32 v55, v50, v55 quad_perm:[2,2,2,2] row_mask:0xf bank_mask:0xf
    v_add_f32 v55, v51, v55 quad_perm:[3,3,3,3] row_mask:0xf bank_mask:0xf
    v_cvt_pk_bf16_f32 v56, v54, v55
    v_lshlrev_b32 v54, 16, v56
    v_and_b32 v55, 0xffff0000, v56
    v_mul_f32 v54, s99, v54
    v_mul_f32 v55, s99, v55
    v_cvt_pk_bf16_f32 v23, v54, v55
    v_max3_f32 v52, v52, v54, v55
    s_waitcnt vmcnt(7)
    buffer_load_dwordx4 v[232:235], v3, s[16:19], s43 offen offset:2048 nt
    v_mfma_f32_16x16x32_bf16 v[36:39], v[96:99], v[4:7], 0
    v_mfma_f32_16x16x32_bf16 v[40:43], v[100:103], v[4:7], 0
    v_mfma_f32_16x16x32_bf16 v[44:47], v[104:107], v[4:7], 0
    v_mfma_f32_16x16x32_bf16 v[48:51], v[108:111], v[4:7], 0
    s_nop 4
    v_mov_b32 v54, v36 quad_perm:[0,0,0,0] row_mask:0xf bank_mask:0xf
    v_add_f32 v54, v37, v54 quad_perm:[1,1,1,1] row_mask:0xf bank_mask:0xf
    v_add_f32 v54, v38, v54 quad_perm:[2,2,2,2] row_mask:0xf bank_mask:0xf
    v_add_f32 v54, v39, v54 quad_perm:[3,3,3,3] row_mask:0xf bank_mask:0xf
    v_mov_b32 v55, v40 quad_perm:[0,0,0,0] row_mask:0xf bank_mask:0xf
    v_add_f32 v55, v41, v55 quad_perm:[1,1,1,1] row_mask:0xf bank_mask:0xf
    v_add_f32 v55, v42, v55 quad_perm:[2,2,2,2] row_mask:0xf bank_mask:0xf
    v_add_f32 v55, v43, v55 quad_perm:[3,3,3,3] row_mask:0xf bank_mask:0xf
    v_cvt_pk_bf16_f32 v56, v54, v55
    v_lshlrev_b32 v54, 16, v56
    v_and_b32 v55, 0xffff0000, v56
    v_mul_f32 v54, s99, v54
    v_mul_f32 v55, s99, v55
    v_cvt_pk_bf16_f32 v24, v54, v55
    v_max3_f32 v52, v52, v54, v55
    v_mov_b32 v54, v44 quad_perm:[0,0,0,0] row_mask:0xf bank_mask:0xf
    v_add_f32 v54, v45, v54 quad_perm:[1,1,1,1] row_mask:0xf bank_mask:0xf
    v_add_f32 v54, v46, v54 quad_perm:[2,2,2,2] row_mask:0xf bank_mask:0xf
    v_add_f32 v54, v47, v54 quad_perm:[3,3,3,3] row_mask:0xf bank_mask:0xf
    v_mov_b32 v55, v48 quad_perm:[0,0,0,0] row_mask:0xf bank_mask:0xf
    v_add_f32 v55, v49, v55 quad_perm:[1,1,1,1] row_mask:0xf bank_mask:0xf
    v_add_f32 v55, v50, v55 quad_perm:[2,2,2,2] row_mask:0xf bank_mask:0xf
    v_add_f32 v55, v51, v55 quad_perm:[3,3,3,3] row_mask:0xf bank_mask:0xf
    v_cvt_pk_bf16_f32 v56, v54, v55
    v_lshlrev_b32 v54, 16, v56
    v_and_b32 v55, 0xffff0000, v56
    v_mul_f32 v54, s99, v54
    v_mul_f32 v55, s99, v55
    v_cvt_pk_bf16_f32 v25, v54, v55
    v_max3_f32 v52, v52, v54, v55
    s_waitcnt vmcnt(7)
    buffer_load_dwordx4 v[236:239], v3, s[16:19], s43 offen offset:3072 nt
    v_mfma_f32_16x16x32_bf16 v[36:39], v[112:115], v[4:7], 0
    v_mfma_f32_16x16x32_bf16 v[40:43], v[116:119], v[4:7], 0
    v_mfma_f32_16x16x32_bf16 v[44:47], v[120:123], v[4:7], 0
    v_mfma_f32_16x16x32_bf16 v[48:51], v[124:127], v[4:7], 0
    s_nop 4
    v_mov_b32 v54, v36 quad_perm:[0,0,0,0] row_mask:0xf bank_mask:0xf
    v_add_f32 v54, v37, v54 quad_perm:[1,1,1,1] row_mask:0xf bank_mask:0xf
    v_add_f32 v54, v38, v54 quad_perm:[2,2,2,2] row_mask:0xf bank_mask:0xf
    v_add_f32 v54, v39, v54 quad_perm:[3,3,3,3] row_mask:0xf bank_mask:0xf
    v_mov_b32 v55, v40 quad_perm:[0,0,0,0] row_mask:0xf bank_mask:0xf
    v_add_f32 v55, v41, v55 quad_perm:[1,1,1,1] row_mask:0xf bank_mask:0xf
    v_add_f32 v55, v42, v55 quad_perm:[2,2,2,2] row_mask:0xf bank_mask:0xf
    v_add_f32 v55, v43, v55 quad_perm:[3,3,3,3] row_mask:0xf bank_mask:0xf
    v_cvt_pk_bf16_f32 v56, v54, v55
    v_lshlrev_b32 v54, 16, v56
    v_and_b32 v55, 0xffff0000, v56
    v_mul_f32 v54, s99, v54
    v_mul_f32 v55, s99, v55
    v_cvt_pk_bf16_f32 v26, v54, v55
    v_max3_f32 v52, v52, v54, v55
    v_mov_b32 v54, v44 quad_perm:[0,0,0,0] row_mask:0xf bank_mask:0xf
    v_add_f32 v54, v45, v54 quad_perm:[1,1,1,1] row_mask:0xf bank_mask:0xf
    v_add_f32 v54, v46, v54 quad_perm:[2,2,2,2] row_mask:0xf bank_mask:0xf
    v_add_f32 v54, v47, v54 quad_perm:[3,3,3,3] row_mask:0xf bank_mask:0xf
    v_mov_b32 v55, v48 quad_perm:[0,0,0,0] row_mask:0xf bank_mask:0xf
    v_add_f32 v55, v49, v55 quad_perm:[1,1,1,1] row_mask:0xf bank_mask:0xf
    v_add_f32 v55, v50, v55 quad_perm:[2,2,2,2] row_mask:0xf bank_mask:0xf
    v_add_f32 v55, v51, v55 quad_perm:[3,3,3,3] row_mask:0xf bank_mask:0xf
    v_cvt_pk_bf16_f32 v56, v54, v55
    v_lshlrev_b32 v54, 16, v56
    v_and_b32 v55, 0xffff0000, v56
    v_mul_f32 v54, s99, v54
    v_mul_f32 v55, s99, v55
    v_cvt_pk_bf16_f32 v27, v54, v55
    v_max3_f32 v52, v52, v54, v55
    s_waitcnt vmcnt(7)
    buffer_load_dwordx4 v[240:243], v3, s[16:19], s44 offen offset:0 nt
    v_mfma_f32_16x16x32_bf16 v[36:39], v[128:131], v[4:7], 0
    v_mfma_f32_16x16x32_bf16 v[40:43], v[132:135], v[4:7], 0
    v_mfma_f32_16x16x32_bf16 v[44:47], v[136:139], v[4:7], 0
    v_mfma_f32_16x16x32_bf16 v[48:51], v[140:143], v[4:7], 0
    s_nop 4
    v_mov_b32 v54, v36 quad_perm:[0,0,0,0] row_mask:0xf bank_mask:0xf
    v_add_f32 v54, v37, v54 quad_perm:[1,1,1,1] row_mask:0xf bank_mask:0xf
    v_add_f32 v54, v38, v54 quad_perm:[2,2,2,2] row_mask:0xf bank_mask:0xf
    v_add_f32 v54, v39, v54 quad_perm:[3,3,3,3] row_mask:0xf bank_mask:0xf
    v_mov_b32 v55, v40 quad_perm:[0,0,0,0] row_mask:0xf bank_mask:0xf
    v_add_f32 v55, v41, v55 quad_perm:[1,1,1,1] row_mask:0xf bank_mask:0xf
    v_add_f32 v55, v42, v55 quad_perm:[2,2,2,2] row_mask:0xf bank_mask:0xf
    v_add_f32 v55, v43, v55 quad_perm:[3,3,3,3] row_mask:0xf bank_mask:0xf
    v_cvt_pk_bf16_f32 v56, v54, v55
    v_lshlrev_b32 v54, 16, v56
    v_and_b32 v55, 0xffff0000, v56
    v_mul_f32 v54, s99, v54
    v_mul_f32 v55, s99, v55
    v_cvt_pk_bf16_f32 v28, v54, v55
    v_max3_f32 v52, v52, v54, v55
    v_mov_b32 v54, v44 quad_perm:[0,0,0,0] row_mask:0xf bank_mask:0xf
    v_add_f32 v54, v45, v54 quad_perm:[1,1,1,1] row_mask:0xf bank_mask:0xf
    v_add_f32 v54, v46, v54 quad_perm:[2,2,2,2] row_mask:0xf bank_mask:0xf
    v_add_f32 v54, v47, v54 quad_perm:[3,3,3,3] row_mask:0xf bank_mask:0xf
    v_mov_b32 v55, v48 quad_perm:[0,0,0,0] row_mask:0xf bank_mask:0xf
    v_add_f32 v55, v49, v55 quad_perm:[1,1,1,1] row_mask:0xf bank_mask:0xf
    v_add_f32 v55, v50, v55 quad_perm:[2,2,2,2] row_mask:0xf bank_mask:0xf
    v_add_f32 v55, v51, v55 quad_perm:[3,3,3,3] row_mask:0xf bank_mask:0xf
    v_cvt_pk_bf16_f32 v56, v54, v55
    v_lshlrev_b32 v54, 16, v56
    v_and_b32 v55, 0xffff0000, v56
    v_mul_f32 v54, s99, v54
    v_mul_f32 v55, s99, v55
    v_cvt_pk_bf16_f32 v29, v54, v55
    v_max3_f32 v52, v52, v54, v55
    s_waitcnt vmcnt(7)
    buffer_load_dwordx4 v[244:247], v3, s[16:19], s44 offen offset:1024 nt
    v_mfma_f32_16x16x32_bf16 v[36:39], v[144:147], v[4:7], 0
    v_mfma_f32_16x16x32_bf16 v[40:43], v[148:151], v[4:7], 0
    v_mfma_f32_16x16x32_bf16 v[44:47], v[152:155], v[4:7], 0
    v_mfma_f32_16x16x32_bf16 v[48:51], v[156:159], v[4:7], 0
    s_nop 4
    v_mov_b32 v54, v36 quad_perm:[0,0,0,0] row_mask:0xf bank_mask:0xf
    v_add_f32 v54, v37, v54 quad_perm:[1,1,1,1] row_mask:0xf bank_mask:0xf
    v_add_f32 v54, v38, v54 quad_perm:[2,2,2,2] row_mask:0xf bank_mask:0xf
    v_add_f32 v54, v39, v54 quad_perm:[3,3,3,3] row_mask:0xf bank_mask:0xf
    v_mov_b32 v55, v40 quad_perm:[0,0,0,0] row_mask:0xf bank_mask:0xf
    v_add_f32 v55, v41, v55 quad_perm:[1,1,1,1] row_mask:0xf bank_mask:0xf
    v_add_f32 v55, v42, v55 quad_perm:[2,2,2,2] row_mask:0xf bank_mask:0xf
    v_add_f32 v55, v43, v55 quad_perm:[3,3,3,3] row_mask:0xf bank_mask:0xf
    v_cvt_pk_bf16_f32 v56, v54, v55
    v_lshlrev_b32 v54, 16, v56
    v_and_b32 v55, 0xffff0000, v56
    v_mul_f32 v54, s99, v54
    v_mul_f32 v55, s99, v55
    v_cvt_pk_bf16_f32 v30, v54, v55
    v_max3_f32 v52, v52, v54, v55
    v_mov_b32 v54, v44 quad_perm:[0,0,0,0] row_mask:0xf bank_mask:0xf
    v_add_f32 v54, v45, v54 quad_perm:[1,1,1,1] row_mask:0xf bank_mask:0xf
    v_add_f32 v54, v46, v54 quad_perm:[2,2,2,2] row_mask:0xf bank_mask:0xf
    v_add_f32 v54, v47, v54 quad_perm:[3,3,3,3] row_mask:0xf bank_mask:0xf
    v_mov_b32 v55, v48 quad_perm:[0,0,0,0] row_mask:0xf bank_mask:0xf
    v_add_f32 v55, v49, v55 quad_perm:[1,1,1,1] row_mask:0xf bank_mask:0xf
    v_add_f32 v55, v50, v55 quad_perm:[2,2,2,2] row_mask:0xf bank_mask:0xf
    v_add_f32 v55, v51, v55 quad_perm:[3,3,3,3] row_mask:0xf bank_mask:0xf
    v_cvt_pk_bf16_f32 v56, v54, v55
    v_lshlrev_b32 v54, 16, v56
    v_and_b32 v55, 0xffff0000, v56
    v_mul_f32 v54, s99, v54
    v_mul_f32 v55, s99, v55
    v_cvt_pk_bf16_f32 v31, v54, v55
    v_max3_f32 v52, v52, v54, v55
    s_waitcnt vmcnt(7)
    buffer_load_dwordx4 v[248:251], v3, s[16:19], s44 offen offset:2048 nt
    v_mfma_f32_16x16x32_bf16 v[36:39], v[160:163], v[4:7], 0
    v_mfma_f32_16x16x32_bf16 v[40:43], v[164:167], v[4:7], 0
    v_mfma_f32_16x16x32_bf16 v[44:47], v[168:171], v[4:7], 0
    v_mfma_f32_16x16x32_bf16 v[48:51], v[172:175], v[4:7], 0
    s_nop 4
    v_mov_b32 v54, v36 quad_perm:[0,0,0,0] row_mask:0xf bank_mask:0xf
    v_add_f32 v54, v37, v54 quad_perm:[1,1,1,1] row_mask:0xf bank_mask:0xf
    v_add_f32 v54, v38, v54 quad_perm:[2,2,2,2] row_mask:0xf bank_mask:0xf
    v_add_f32 v54, v39, v54 quad_perm:[3,3,3,3] row_mask:0xf bank_mask:0xf
    v_mov_b32 v55, v40 quad_perm:[0,0,0,0] row_mask:0xf bank_mask:0xf
    v_add_f32 v55, v41, v55 quad_perm:[1,1,1,1] row_mask:0xf bank_mask:0xf
    v_add_f32 v55, v42, v55 quad_perm:[2,2,2,2] row_mask:0xf bank_mask:0xf
    v_add_f32 v55, v43, v55 quad_perm:[3,3,3,3] row_mask:0xf bank_mask:0xf
    v_cvt_pk_bf16_f32 v56, v54, v55
    v_lshlrev_b32 v54, 16, v56
    v_and_b32 v55, 0xffff0000, v56
    v_mul_f32 v54, s99, v54
    v_mul_f32 v55, s99, v55
    v_cvt_pk_bf16_f32 v32, v54, v55
    v_max3_f32 v52, v52, v54, v55
    v_mov_b32 v54, v44 quad_perm:[0,0,0,0] row_mask:0xf bank_mask:0xf
    v_add_f32 v54, v45, v54 quad_perm:[1,1,1,1] row_mask:0xf bank_mask:0xf
    v_add_f32 v54, v46, v54 quad_perm:[2,2,2,2] row_mask:0xf bank_mask:0xf
    v_add_f32 v54, v47, v54 quad_perm:[3,3,3,3] row_mask:0xf bank_mask:0xf
    v_mov_b32 v55, v48 quad_perm:[0,0,0,0] row_mask:0xf bank_mask:0xf
    v_add_f32 v55, v49, v55 quad_perm:[1,1,1,1] row_mask:0xf bank_mask:0xf
    v_add_f32 v55, v50, v55 quad_perm:[2,2,2,2] row_mask:0xf bank_mask:0xf
    v_add_f32 v55, v51, v55 quad_perm:[3,3,3,3] row_mask:0xf bank_mask:0xf
    v_cvt_pk_bf16_f32 v56, v54, v55
    v_lshlrev_b32 v54, 16, v56
    v_and_b32 v55, 0xffff0000, v56
    v_mul_f32 v54, s99, v54
    v_mul_f32 v55, s99, v55
    v_cvt_pk_bf16_f32 v33, v54, v55
    v_max3_f32 v52, v52, v54, v55
    s_waitcnt vmcnt(7)
    buffer_load_dwordx4 v[252:255], v3, s[16:19], s44 offen offset:3072 nt
    v_mov_b32 v53, v52
    s_nop 1
    v_permlane16_swap_b32 v52, v53
    v_max_f32 v52, v52, v53
    v_mov_b32 v53, v52
    s_nop 1
    v_permlane32_swap_b32 v52, v53
    v_max_f32 v52, v52, v53
    v_cvt_pk_bf16_f32 v52, v52, v52
    v_and_b32 v52, 0xffff0000, v52
    s_mov_b32 s69, 1069066811
    v_mul_f32 v53, s69, v52
    v_mov_b32 v57, 0
    v_mov_b32 v58, 0
    v_bfe_u32 v54, v1, 2, 2
    v_lshlrev_b32 v54, 5, v54
    s_lshl_b32 s7, s3, 2
    v_add_u32 v55, s7, v54
    ds_write_b32 v55, v52 offset:6208
    v_mov_b32 v54, 6152
    v_mov_b32 v55, 1
    s_mov_b64 exec, 1
    ds_add_u32 v54, v55
    s_mov_b64 exec, -1
    v_mov_b32 v12, 0
    v_mov_b32 v13, 0
    v_mov_b32 v14, 0
    v_mov_b32 v15, 0
    v_mov_b32 v16, 0
    v_mov_b32 v17, 0
    v_mov_b32 v18, 0
    v_mov_b32 v19, 0
    v_lshlrev_b32 v36, 16, v20
    v_and_b32 v37, 0xffff0000, v20
    v_fma_f32 v36, v36, s69, -v53
    v_fma_f32 v37, v37, s69, -v53
    v_exp_f32 v36, v36
    v_exp_f32 v37, v37
    v_add_f32 v57, v57, v36
    v_add_f32 v58, v58, v37
    v_cvt_pk_bf16_f32 v20, v36, v37
    v_lshlrev_b32 v38, 16, v21
    v_and_b32 v39, 0xffff0000, v21
    v_fma_f32 v38, v38, s69, -v53
    v_fma_f32 v39, v39, s69, -v53
    v_exp_f32 v38, v38
    v_exp_f32 v39, v39
    v_add_f32 v57, v57, v38
    v_add_f32 v58, v58, v39
    v_cvt_pk_bf16_f32 v21, v38, v39
    v_lshlrev_b32 v36, 16, v22
    v_and_b32 v37, 0xffff0000, v22
    v_fma_f32 v36, v36, s69, -v53
    v_fma_f32 v37, v37, s69, -v53
    v_exp_f32 v36, v36
    v_exp_f32 v37, v37
    v_add_f32 v57, v57, v36
    v_add_f32 v58, v58, v37
    v_cvt_pk_bf16_f32 v22, v36, v37
    v_lshlrev_b32 v38, 16, v23
    v_and_b32 v39, 0xffff0000, v23
    v_fma_f32 v38, v38, s69, -v53
    v_fma_f32 v39, v39, s69, -v53
    v_exp_f32 v38, v38
    v_exp_f32 v39, v39
    v_add_f32 v57, v57, v38
    v_add_f32 v58, v58, v39
    v_cvt_pk_bf16_f32 v23, v38, v39
    v_lshlrev_b32 v36, 16, v24
    v_and_b32 v37, 0xffff0000, v24
    v_fma_f32 v36, v36, s69, -v53
    v_fma_f32 v37, v37, s69, -v53
    v_exp_f32 v36, v36
    v_exp_f32 v37, v37
    v_add_f32 v57, v57, v36
    v_add_f32 v58, v58, v37
    v_cvt_pk_bf16_f32 v24, v36, v37
    v_lshlrev_b32 v38, 16, v25
    v_and_b32 v39, 0xffff0000, v25
    v_fma_f32 v38, v38, s69, -v53
    v_fma_f32 v39, v39, s69, -v53
    v_exp_f32 v38, v38
    v_exp_f32 v39, v39
    v_add_f32 v57, v57, v38
    v_add_f32 v58, v58, v39
    v_cvt_pk_bf16_f32 v25, v38, v39
    v_and_b32 v134, 3, v1
    v_lshlrev_b32 v134, 9, v134
    v_lshrrev_b32 v133, 4, v1
    v_lshl_add_u32 v134, v133, 4, v134
    v_bfe_u32 v133, v1, 2, 1
    v_mul_u32_u24 v133, 57344, v133
    v_add_u32 v134, v134, v133
    s_mul_i32 s96, s4, 28
    s_add_u32 s96, s96, s5
    s_lshl_b32 s97, s96, 13
    s_lshl_b32 s7, s3, 7
    s_add_u32 s97, s97, s7
    s_lshr_b32 s7, s96, 3
    s_lshl_b32 s7, s7, 11
    s_and_b32 s96, s96, 7
    s_lshl_b32 s96, s96, 6
    s_add_u32 s96, s96, s7
    s_add_u32 s96, s96, 393216
    s_cmp_lt_u32 s5, 28
    s_cselect_b32 s96, s96, 1073741824
    s_cselect_b32 s97, s97, 1073741824
    s_cselect_b32 s98, s6, 0
    buffer_load_dwordx4 v[128:131], v134, s[64:67], s96 offen sc1
    s_waitcnt vmcnt(8)
    buffer_load_dwordx4 v[64:67], v3, s[16:19], s45 offen offset:0 nt
    v_lshlrev_b32 v36, 16, v26
    v_and_b32 v37, 0xffff0000, v26
    v_fma_f32 v36, v36, s69, -v53
    v_fma_f32 v37, v37, s69, -v53
    v_exp_f32 v36, v36
    v_exp_f32 v37, v37
    v_add_f32 v57, v57, v36
    v_add_f32 v58, v58, v37
    v_cvt_pk_bf16_f32 v26, v36, v37
    v_lshlrev_b32 v38, 16, v27
    v_and_b32 v39, 0xffff0000, v27
    v_fma_f32 v38, v38, s69, -v53
    v_fma_f32 v39, v39, s69, -v53
    v_exp_f32 v38, v38
    v_exp_f32 v39, v39
    v_add_f32 v57, v57, v38
    v_add_f32 v58, v58, v39
    v_cvt_pk_bf16_f32 v27, v38, v39
    v_lshlrev_b32 v36, 16, v28
    v_and_b32 v37, 0xffff0000, v28
    v_fma_f32 v36, v36, s69, -v53
    v_fma_f32 v37, v37, s69, -v53
    v_exp_f32 v36, v36
    v_exp_f32 v37, v37
    v_add_f32 v57, v57, v36
    v_add_f32 v58, v58, v37
    v_cvt_pk_bf16_f32 v28, v36, v37
    v_lshlrev_b32 v38, 16, v29
    v_and_b32 v39, 0xffff0000, v29
    v_fma_f32 v38, v38, s69, -v53
    v_fma_f32 v39, v39, s69, -v53
    v_exp_f32 v38, v38
    v_exp_f32 v39, v39
    v_add_f32 v57, v57, v38
    v_add_f32 v58, v58, v39
    v_cvt_pk_bf16_f32 v29, v38, v39
    v_lshlrev_b32 v36, 16, v30
    v_and_b32 v37, 0xffff0000, v30
    v_fma_f32 v36, v36, s69, -v53
    v_fma_f32 v37, v37, s69, -v53
    v_exp_f32 v36, v36
    v_exp_f32 v37, v37
    v_add_f32 v57, v57, v36
    v_add_f32 v58, v58, v37
    v_cvt_pk_bf16_f32 v30, v36, v37
    v_lshlrev_b32 v38, 16, v31
    v_and_b32 v39, 0xffff0000, v31
    v_fma_f32 v38, v38, s69, -v53
    v_fma_f32 v39, v39, s69, -v53
    v_exp_f32 v38, v38
    v_exp_f32 v39, v39
    v_add_f32 v57, v57, v38
    v_add_f32 v58, v58, v39
    v_cvt_pk_bf16_f32 v31, v38, v39
    v_lshlrev_b32 v36, 16, v32
    v_and_b32 v37, 0xffff0000, v32
    v_fma_f32 v36, v36, s69, -v53
    v_fma_f32 v37, v37, s69, -v53
    v_exp_f32 v36, v36
    v_exp_f32 v37, v37
    v_add_f32 v57, v57, v36
    v_add_f32 v58, v58, v37
    v_cvt_pk_bf16_f32 v32, v36, v37
    v_lshlrev_b32 v38, 16, v33
    v_and_b32 v39, 0xffff0000, v33
    v_fma_f32 v38, v38, s69, -v53
    v_fma_f32 v39, v39, s69, -v53
    v_exp_f32 v38, v38
    v_exp_f32 v39, v39
    v_add_f32 v57, v57, v38
    v_add_f32 v58, v58, v39
    v_cvt_pk_bf16_f32 v33, v38, v39
    s_waitcnt vmcnt(8)
    buffer_load_dwordx4 v[68:71], v3, s[16:19], s45 offen offset:1024 nt
    v_perm_b32 v36, v20, v20, v8
    v_perm_b32 v37, v20, v20, v9
    s_nop 1
    v_mfma_f32_16x16x16_bf16 v[12:15], v[36:37], v[176:177], v[12:15]
    v_mfma_f32_16x16x16_bf16 v[16:19], v[36:37], v[178:179], v[16:19]
    v_perm_b32 v38, v20, v20, v10
    v_perm_b32 v39, v20, v20, v11
    s_nop 1
    v_mfma_f32_16x16x16_bf16 v[12:15], v[38:39], v[180:181], v[12:15]
    v_mfma_f32_16x16x16_bf16 v[16:19], v[38:39], v[182:183], v[16:19]
    v_perm_b32 v40, v21, v21, v8
    v_perm_b32 v41, v21, v21, v9
    s_nop 1
    v_mfma_f32_16x16x16_bf16 v[12:15], v[40:41], v[184:185], v[12:15]
    v_mfma_f32_16x16x16_bf16 v[16:19], v[40:41], v[186:187], v[16:19]
    v_perm_b32 v42, v21, v21, v10
    v_perm_b32 v43, v21, v21, v11
    s_nop 1
    v_mfma_f32_16x16x16_bf16 v[12:15], v[42:43], v[188:189], v[12:15]
    v_mfma_f32_16x16x16_bf16 v[16:19], v[42:43], v[190:191], v[16:19]
    s_waitcnt vmcnt(8)
    buffer_load_dwordx4 v[72:75], v3, s[16:19], s45 offen offset:2048 nt
    v_perm_b32 v36, v22, v22, v8
    v_perm_b32 v37, v22, v22, v9
    s_nop 1
    v_mfma_f32_16x16x16_bf16 v[12:15], v[36:37], v[192:193], v[12:15]
    v_mfma_f32_16x16x16_bf16 v[16:19], v[36:37], v[194:195], v[16:19]
    v_perm_b32 v38, v22, v22, v10
    v_perm_b32 v39, v22, v22, v11
    s_nop 1
    v_mfma_f32_16x16x16_bf16 v[12:15], v[38:39], v[196:197], v[12:15]
    v_mfma_f32_16x16x16_bf16 v[16:19], v[38:39], v[198:199], v[16:19]
    v_perm_b32 v40, v23, v23, v8
    v_perm_b32 v41, v23, v23, v9
    s_nop 1
    v_mfma_f32_16x16x16_bf16 v[12:15], v[40:41], v[200:201], v[12:15]
    v_mfma_f32_16x16x16_bf16 v[16:19], v[40:41], v[202:203], v[16:19]
    v_perm_b32 v42, v23, v23, v10
    v_perm_b32 v43, v23, v23, v11
    s_nop 1
    v_mfma_f32_16x16x16_bf16 v[12:15], v[42:43], v[204:205], v[12:15]
    v_mfma_f32_16x16x16_bf16 v[16:19], v[42:43], v[206:207], v[16:19]
    s_waitcnt vmcnt(8)
    buffer_load_dwordx4 v[76:79], v3, s[16:19], s45 offen offset:3072 nt
    v_perm_b32 v36, v24, v24, v8
    v_perm_b32 v37, v24, v24, v9
    s_nop 1
    v_mfma_f32_16x16x16_bf16 v[12:15], v[36:37], v[208:209], v[12:15]
    v_mfma_f32_16x16x16_bf16 v[16:19], v[36:37], v[210:211], v[16:19]
    v_perm_b32 v38, v24, v24, v10
    v_perm_b32 v39, v24, v24, v11
    s_nop 1
    v_mfma_f32_16x16x16_bf16 v[12:15], v[38:39], v[212:213], v[12:15]
    v_mfma_f32_16x16x16_bf16 v[16:19], v[38:39], v[214:215], v[16:19]
    v_perm_b32 v40, v25, v25, v8
    v_perm_b32 v41, v25, v25, v9
    s_nop 1
    v_mfma_f32_16x16x16_bf16 v[12:15], v[40:41], v[216:217], v[12:15]
    v_mfma_f32_16x16x16_bf16 v[16:19], v[40:41], v[218:219], v[16:19]
    v_perm_b32 v42, v25, v25, v10
    v_perm_b32 v43, v25, v25, v11
    s_nop 1
    v_mfma_f32_16x16x16_bf16 v[12:15], v[42:43], v[220:221], v[12:15]
    v_mfma_f32_16x16x16_bf16 v[16:19], v[42:43], v[222:223], v[16:19]
    s_waitcnt vmcnt(8)
    v_mov_b32 v61, 1
    s_mov_b64 exec, 1
    buffer_atomic_add v61, off, s[64:67], s53 sc0 sc1
    s_mov_b64 exec, -1
    buffer_load_dwordx4 v[80:83], v3, s[16:19], s46 offen offset:0 nt
    v_perm_b32 v36, v26, v26, v8
    v_perm_b32 v37, v26, v26, v9
    s_nop 1
    v_mfma_f32_16x16x16_bf16 v[12:15], v[36:37], v[224:225], v[12:15]
    v_mfma_f32_16x16x16_bf16 v[16:19], v[36:37], v[226:227], v[16:19]
    v_perm_b32 v38, v26, v26, v10
    v_perm_b32 v39, v26, v26, v11
    s_nop 1
    v_mfma_f32_16x16x16_bf16 v[12:15], v[38:39], v[228:229], v[12:15]
    v_mfma_f32_16x16x16_bf16 v[16:19], v[38:39], v[230:231], v[16:19]
    v_perm_b32 v40, v27, v27, v8
    v_perm_b32 v41, v27, v27, v9
    s_nop 1
    v_mfma_f32_16x16x16_bf16 v[12:15], v[40:41], v[232:233], v[12:15]
    v_mfma_f32_16x16x16_bf16 v[16:19], v[40:41], v[234:235], v[16:19]
    v_perm_b32 v42, v27, v27, v10
    v_perm_b32 v43, v27, v27, v11
    s_nop 1
    v_mfma_f32_16x16x16_bf16 v[12:15], v[42:43], v[236:237], v[12:15]
    v_mfma_f32_16x16x16_bf16 v[16:19], v[42:43], v[238:239], v[16:19]
    s_waitcnt vmcnt(9)
    buffer_load_dwordx4 v[84:87], v3, s[16:19], s46 offen offset:1024 nt
    v_perm_b32 v36, v28, v28, v8
    v_perm_b32 v37, v28, v28, v9
    s_nop 1
    v_mfma_f32_16x16x16_bf16 v[12:15], v[36:37], v[240:241], v[12:15]
    v_mfma_f32_16x16x16_bf16 v[16:19], v[36:37], v[242:243], v[16:19]
    v_perm_b32 v38, v28, v28, v10
    v_perm_b32 v39, v28, v28, v11
    s_nop 1
    v_mfma_f32_16x16x16_bf16 v[12:15], v[38:39], v[244:245], v[12:15]
    v_mfma_f32_16x16x16_bf16 v[16:19], v[38:39], v[246:247], v[16:19]
    v_lshrrev_b32 v138, 3, v0
    v_mul_u32_u24 v138, 4224, v138
    v_and_b32 v136, 7, v0
    v_lshl_add_u32 v138, v136, 4, v138
    s_mul_i32 s68, s4, 135168
    s_add_u32 s68, s68, 2097152
    s_lshl_b32 s7, s5, 7
    s_add_u32 s68, s68, s7
    s_mul_i32 s71, s2, 4224
    s_add_u32 s71, s71, 2097152
    s_lshl_b32 s50, s2, 14
    s_add_u32 s50, s50, 4194304
    s_cmp_lt_u32 s2, 64
    s_cselect_b32 s50, s50, 1073741824
    v_lshlrev_b32 v136, 4, v136
    v_lshrrev_b32 v36, 3, v1
    v_lshl_add_u32 v137, v36, 10, v136
    v_lshl_add_u32 v136, v36, 11, v136
    s_lshl_b32 s48, s2, 14
    s_lshl_b32 s7, s3, 7
    s_add_u32 s48, s48, s7
    v_lshlrev_b32 v152, 5, v0
    v_lshlrev_b32 v168, 3, v0
    v_bfe_u32 v154, v1, 2, 2
    v_lshlrev_b32 v154, 5, v154
    s_lshl_b32 s7, s3, 2
    v_add_u32 v153, s7, v154
    v_mov_b32 v154, 6160
    s_and_b32 s7, s3, 3
    s_lshl_b32 s7, s7, 5
    v_mov_b32 v155, s7
    v_mov_b32 v175, s6
    s_waitcnt vmcnt(9)
    buffer_load_dwordx4 v[88:91], v3, s[16:19], s46 offen offset:2048 nt
    v_perm_b32 v40, v29, v29, v8
    v_perm_b32 v41, v29, v29, v9
    s_nop 1
    v_mfma_f32_16x16x16_bf16 v[12:15], v[40:41], v[248:249], v[12:15]
    v_mfma_f32_16x16x16_bf16 v[16:19], v[40:41], v[250:251], v[16:19]
    v_mov_b32 v140, 6152
    s_mov_b32 s49, 3200000
    s_nop 5
L_sp_8:
    ds_read_b32 v141, v140
    s_waitcnt lgkmcnt(0)
    v_readfirstlane_b32 s7, v141
    s_sub_u32 s49, s49, 1
    s_cbranch_scc1 L_spd_9
    s_cmp_eq_u32 s7, 8
    s_cbranch_scc1 L_spd_9
    s_sleep 1
    s_branch L_sp_8
L_spd_9:
    v_bfe_u32 v140, v1, 2, 2
    v_lshlrev_b32 v140, 5, v140
    s_lshl_b32 s7, s3, 2
    v_add_u32 v141, s7, v140
    ds_read_b128 v[144:147], v140 offset:6208
    ds_read_b128 v[148:151], v140 offset:6224
    v_and_b32 v141, 0x30, v1
    s_and_b32 s7, s3, 3
    s_lshl_b32 s7, s7, 2
    s_waitcnt lgkmcnt(0)
    v_max3_f32 v144, v144, v145, v146
    v_max3_f32 v148, v148, v149, v150
    v_max3_f32 v144, v144, v147, v151
    v_max_f32 v144, v144, v148
    v_sub_f32 v60, v52, v144
    v_mul_f32 v60, s69, v60
    v_exp_f32 v60, v60
    v_readlane_b32 s7, v144, s7
    s_nop 0
    ds_bpermute_b32 v59, v141, v60
    v_mov_b32 v142, s7
    s_waitcnt lgkmcnt(0)
    s_waitcnt vmcnt(9)
    buffer_load_dwordx4 v[92:95], v3, s[16:19], s46 offen offset:3072 nt
    v_perm_b32 v42, v29, v29, v10
    v_perm_b32 v43, v29, v29, v11
    s_nop 1
    v_mfma_f32_16x16x16_bf16 v[12:15], v[42:43], v[252:253], v[12:15]
    v_mfma_f32_16x16x16_bf16 v[16:19], v[42:43], v[254:255], v[16:19]
    s_waitcnt vmcnt(9)
    s_mov_b32 s49, 400000
    s_nop 5
L_fl_10:
    v_cmp_ne_u32 vcc, s98, v131
    s_sub_u32 s49, s49, 1
    s_cbranch_scc1 L_fk_11
    s_nop 2
    s_cbranch_vccz L_fk_11
    s_sleep 2
    buffer_load_dwordx4 v[128:131], v134, s[64:67], s96 offen sc1
    s_waitcnt vmcnt(0)
    s_branch L_fl_10
L_fk_11:
    v_and_b32 v132, 8, v1
    v_cmp_ne_u32 vcc, 0, v132
    s_nop 1
    v_cndmask_b32 v128, v128, v129, vcc
    s_nop 1
    v_add_f32 v128, v128, v128 quad_perm:[1,0,3,2] row_mask:0xf bank_mask:0xf
    s_nop 1
    v_add_f32 v128, v128, v128 quad_perm:[2,3,0,1] row_mask:0xf bank_mask:0xf
    v_cvt_pk_bf16_f32 v128, v128, v128
    v_and_b32 v128, 0xffff0000, v128
    s_nop 1
    v_mov_b32 v129, v128 row_half_mirror row_mask:0xf bank_mask:0xf
    v_and_b32 v132, 4, v1
    v_cmp_ne_u32 vcc, 0, v132
    s_nop 1
    v_cndmask_b32 v130, v128, v129, vcc
    v_cndmask_b32 v131, v129, v128, vcc
    v_mul_f32 v129, v130, v130
    v_mul_f32 v129, v129, v130
    v_mov_b32 v132, 0x3d372713
    v_fma_f32 v129, v129, v132, v130
    v_mul_f32 v129, 0xc0135761, v129
    v_exp_f32 v129, v129
    s_nop 0
    v_add_f32 v129, 1.0, v129
    v_rcp_f32 v129, v129
    s_nop 0
    v_mul_f32 v129, v129, v130
    v_cvt_pk_bf16_f32 v129, v129, v129
    v_and_b32 v129, 0xffff0000, v129
    v_mul_f32 v129, v129, v131
    v_cvt_pk_bf16_f32 v139, v129, v129
    v_and_b32 v139, 0xffff0000, v139
    s_waitcnt vmcnt(4)
    v_readfirstlane_b32 s7, v61
    s_nop 0
    s_cmp_lt_u32 s7, 64
    s_cselect_b32 s56, 0, 1
    s_cselect_b32 s53, s53, 1073741824
    s_cselect_b32 s52, s52, 1073741824
    s_lshl_b32 s7, s7, 11
    s_add_u32 s7, s7, s52
    v_mov_b32 v61, 1
    s_mov_b64 exec, 1
    buffer_atomic_add v61, off, s[64:67], s53 sc0 sc1
    s_mov_b64 exec, -1
    buffer_load_dwordx4 v[96:99], v2, s[12:15], s7 offen offset:0 nt
    buffer_load_dwordx4 v[100:103], v2, s[12:15], s7 offen offset:1024 nt
    buffer_load_dwordx4 v[104:107], v3, s[16:19], s7 offen offset:0 nt
    buffer_load_dwordx4 v[108:111], v3, s[16:19], s7 offen offset:1024 nt
    v_perm_b32 v36, v30, v30, v8
    v_perm_b32 v37, v30, v30, v9
    s_nop 1
    v_mfma_f32_16x16x16_bf16 v[12:15], v[36:37], v[64:65], v[12:15]
    v_mfma_f32_16x16x16_bf16 v[16:19], v[36:37], v[66:67], v[16:19]
    v_perm_b32 v38, v30, v30, v10
    v_perm_b32 v39, v30, v30, v11
    s_nop 1
    v_mfma_f32_16x16x16_bf16 v[12:15], v[38:39], v[68:69], v[12:15]
    v_mfma_f32_16x16x16_bf16 v[16:19], v[38:39], v[70:71], v[16:19]
    v_perm_b32 v40, v31, v31, v8
    v_perm_b32 v41, v31, v31, v9
    s_nop 1
    v_mfma_f32_16x16x16_bf16 v[12:15], v[40:41], v[72:73], v[12:15]
    v_mfma_f32_16x16x16_bf16 v[16:19], v[40:41], v[74:75], v[16:19]
    v_perm_b32 v42, v31, v31, v10
    v_perm_b32 v43, v31, v31, v11
    s_nop 1
    v_mfma_f32_16x16x16_bf16 v[12:15], v[42:43], v[76:77], v[12:15]
    v_mfma_f32_16x16x16_bf16 v[16:19], v[42:43], v[78:79], v[16:19]
    v_perm_b32 v36, v32, v32, v8
    v_perm_b32 v37, v32, v32, v9
    s_waitcnt vmcnt(8)
    s_nop 0
    v_mfma_f32_16x16x16_bf16 v[12:15], v[36:37], v[80:81], v[12:15]
    v_mfma_f32_16x16x16_bf16 v[16:19], v[36:37], v[82:83], v[16:19]
    v_perm_b32 v38, v32, v32, v10
    v_perm_b32 v39, v32, v32, v11
    s_waitcnt vmcnt(7)
    s_nop 0
    v_mfma_f32_16x16x16_bf16 v[12:15], v[38:39], v[84:85], v[12:15]
    v_mfma_f32_16x16x16_bf16 v[16:19], v[38:39], v[86:87], v[16:19]
    v_perm_b32 v40, v33, v33, v8
    v_perm_b32 v41, v33, v33, v9
    s_waitcnt vmcnt(6)
    s_nop 0
    v_mfma_f32_16x16x16_bf16 v[12:15], v[40:41], v[88:89], v[12:15]
    v_mfma_f32_16x16x16_bf16 v[16:19], v[40:41], v[90:91], v[16:19]
    v_perm_b32 v42, v33, v33, v10
    v_perm_b32 v43, v33, v33, v11
    s_waitcnt vmcnt(5)
    s_nop 0
    v_mfma_f32_16x16x16_bf16 v[12:15], v[42:43], v[92:93], v[12:15]
    v_mfma_f32_16x16x16_bf16 v[16:19], v[42:43], v[94:95], v[16:19]
    s_cmp_lg_u32 s56, 0
    s_nop 6
    s_cbranch_scc1 L_fin
    s_waitcnt vmcnt(4)
    v_readfirstlane_b32 s7, v61
    s_nop 0
    s_cmp_lt_u32 s7, 64
    s_cselect_b32 s56, 0, 1
    s_cselect_b32 s53, s53, 1073741824
    s_cselect_b32 s52, s52, 1073741824
    s_lshl_b32 s7, s7, 11
    s_add_u32 s7, s7, s52
    v_mov_b32 v61, 1
    s_mov_b64 exec, 1
    buffer_atomic_add v61, off, s[64:67], s53 sc0 sc1
    s_mov_b64 exec, -1
    buffer_load_dwordx4 v[112:115], v2, s[12:15], s7 offen offset:0 nt
    buffer_load_dwordx4 v[116:119], v2, s[12:15], s7 offen offset:1024 nt
    buffer_load_dwordx4 v[120:123], v3, s[16:19], s7 offen offset:0 nt
    buffer_load_dwordx4 v[124:127], v3, s[16:19], s7 offen offset:1024 nt
L_dyn0:
    s_waitcnt vmcnt(7)
    v_mfma_f32_16x16x32_bf16 v[36:39], v[96:99], v[4:7], 0
    v_mfma_f32_16x16x32_bf16 v[40:43], v[100:103], v[4:7], 0
    s_nop 6
    v_mov_b32 v54, v36 quad_perm:[0,0,0,0] row_mask:0xf bank_mask:0xf
    v_add_f32 v54, v37, v54 quad_perm:[1,1,1,1] row_mask:0xf bank_mask:0xf
    v_add_f32 v54, v38, v54 quad_perm:[2,2,2,2] row_mask:0xf bank_mask:0xf
    v_add_f32 v54, v39, v54 quad_perm:[3,3,3,3] row_mask:0xf bank_mask:0xf
    v_mov_b32 v55, v40 quad_perm:[0,0,0,0] row_mask:0xf bank_mask:0xf
    v_add_f32 v55, v41, v55 quad_perm:[1,1,1,1] row_mask:0xf bank_mask:0xf
    v_add_f32 v55, v42, v55 quad_perm:[2,2,2,2] row_mask:0xf bank_mask:0xf
    v_add_f32 v55, v43, v55 quad_perm:[3,3,3,3] row_mask:0xf bank_mask:0xf
    v_cvt_pk_bf16_f32 v56, v54, v55
    v_lshlrev_b32 v54, 16, v56
    v_and_b32 v55, 0xffff0000, v56
    v_mul_f32 v54, s99, v54
    v_mul_f32 v55, s99, v55
    v_cvt_pk_bf16_f32 v56, v54, v55
    v_lshlrev_b32 v54, 16, v56
    v_and_b32 v55, 0xffff0000, v56
    v_fma_f32 v36, v54, s69, -v53
    v_fma_f32 v37, v55, s69, -v53
    v_max_f32 v38, v36, v37
    s_mov_b32 s51, 0
    v_cmp_lt_f32 vcc, 0x42000000, v38
    s_nop 4
    s_cbranch_vccnz L_slow
L_slowr0:
    v_exp_f32 v36, v36
    v_exp_f32 v37, v37
    v_add_f32 v57, v57, v36
    v_add_f32 v58, v58, v37
    v_cvt_pk_bf16_f32 v20, v36, v37
    v_perm_b32 v40, v20, v20, v8
    v_perm_b32 v41, v20, v20, v9
    s_waitcnt vmcnt(6)
    s_nop 0
    v_mfma_f32_16x16x16_bf16 v[12:15], v[40:41], v[104:105], v[12:15]
    v_mfma_f32_16x16x16_bf16 v[16:19], v[40:41], v[106:107], v[16:19]
    v_perm_b32 v42, v20, v20, v10
    v_perm_b32 v43, v20, v20, v11
    s_waitcnt vmcnt(5)
    s_nop 0
    v_mfma_f32_16x16x16_bf16 v[12:15], v[42:43], v[108:109], v[12:15]
    v_mfma_f32_16x16x16_bf16 v[16:19], v[42:43], v[110:111], v[16:19]
    s_cmp_lg_u32 s56, 0
    s_nop 6
    s_cbranch_scc1 L_fin
    s_waitcnt vmcnt(4)
    v_readfirstlane_b32 s7, v61
    s_nop 0
    s_cmp_lt_u32 s7, 64
    s_cselect_b32 s56, 0, 1
    s_cselect_b32 s53, s53, 1073741824
    s_cselect_b32 s52, s52, 1073741824
    s_lshl_b32 s7, s7, 11
    s_add_u32 s7, s7, s52
    v_mov_b32 v61, 1
    s_mov_b64 exec, 1
    buffer_atomic_add v61, off, s[64:67], s53 sc0 sc1
    s_mov_b64 exec, -1
    buffer_load_dwordx4 v[96:99], v2, s[12:15], s7 offen offset:0 nt
    buffer_load_dwordx4 v[100:103], v2, s[12:15], s7 offen offset:1024 nt
    buffer_load_dwordx4 v[104:107], v3, s[16:19], s7 offen offset:0 nt
    buffer_load_dwordx4 v[108:111], v3, s[16:19], s7 offen offset:1024 nt
L_dyn1:
    s_waitcnt vmcnt(7)
    v_mfma_f32_16x16x32_bf16 v[36:39], v[112:115], v[4:7], 0
    v_mfma_f32_16x16x32_bf16 v[40:43], v[116:119], v[4:7], 0
    s_nop 6
    v_mov_b32 v54, v36 quad_perm:[0,0,0,0] row_mask:0xf bank_mask:0xf
    v_add_f32 v54, v37, v54 quad_perm:[1,1,1,1] row_mask:0xf bank_mask:0xf
    v_add_f32 v54, v38, v54 quad_perm:[2,2,2,2] row_mask:0xf bank_mask:0xf
    v_add_f32 v54, v39, v54 quad_perm:[3,3,3,3] row_mask:0xf bank_mask:0xf
    v_mov_b32 v55, v40 quad_perm:[0,0,0,0] row_mask:0xf bank_mask:0xf
    v_add_f32 v55, v41, v55 quad_perm:[1,1,1,1] row_mask:0xf bank_mask:0xf
    v_add_f32 v55, v42, v55 quad_perm:[2,2,2,2] row_mask:0xf bank_mask:0xf
    v_add_f32 v55, v43, v55 quad_perm:[3,3,3,3] row_mask:0xf bank_mask:0xf
    v_cvt_pk_bf16_f32 v56, v54, v55
    v_lshlrev_b32 v54, 16, v56
    v_and_b32 v55, 0xffff0000, v56
    v_mul_f32 v54, s99, v54
    v_mul_f32 v55, s99, v55
    v_cvt_pk_bf16_f32 v56, v54, v55
    v_lshlrev_b32 v54, 16, v56
    v_and_b32 v55, 0xffff0000, v56
    v_fma_f32 v36, v54, s69, -v53
    v_fma_f32 v37, v55, s69, -v53
    v_max_f32 v38, v36, v37
    s_mov_b32 s51, 1
    v_cmp_lt_f32 vcc, 0x42000000, v38
    s_nop 4
    s_cbranch_vccnz L_slow
L_slowr1:
    v_exp_f32 v36, v36
    v_exp_f32 v37, v37
    v_add_f32 v57, v57, v36
    v_add_f32 v58, v58, v37
    v_cvt_pk_bf16_f32 v20, v36, v37
    v_perm_b32 v40, v20, v20, v8
    v_perm_b32 v41, v20, v20, v9
    s_waitcnt vmcnt(6)
    s_nop 0
    v_mfma_f32_16x16x16_bf16 v[12:15], v[40:41], v[120:121], v[12:15]
    v_mfma_f32_16x16x16_bf16 v[16:19], v[40:41], v[122:123], v[16:19]
    v_perm_b32 v42, v20, v20, v10
    v_perm_b32 v43, v20, v20, v11
    s_waitcnt vmcnt(5)
    s_nop 0
    v_mfma_f32_16x16x16_bf16 v[12:15], v[42:43], v[124:125], v[12:15]
    v_mfma_f32_16x16x16_bf16 v[16:19], v[42:43], v[126:127], v[16:19]
    s_cmp_lg_u32 s56, 0
    s_nop 6
    s_cbranch_scc1 L_fin
    s_waitcnt vmcnt(4)
    v_readfirstlane_b32 s7, v61
    s_nop 0
    s_cmp_lt_u32 s7, 64
    s_cselect_b32 s56, 0, 1
    s_cselect_b32 s53, s53, 1073741824
    s_cselect_b32 s52, s52, 1073741824
    s_lshl_b32 s7, s7, 11
    s_add_u32 s7, s7, s52
    v_mov_b32 v61, 1
    s_mov_b64 exec, 1
    buffer_atomic_add v61, off, s[64:67], s53 sc0 sc1
    s_mov_b64 exec, -1
    buffer_load_dwordx4 v[112:115], v2, s[12:15], s7 offen offset:0 nt
    buffer_load_dwordx4 v[116:119], v2, s[12:15], s7 offen offset:1024 nt
    buffer_load_dwordx4 v[120:123], v3, s[16:19], s7 offen offset:0 nt
    buffer_load_dwordx4 v[124:127], v3, s[16:19], s7 offen offset:1024 nt
    s_branch L_dyn0
L_fin:
    s_cmp_eq_u32 s3, 0
    s_cbranch_scc0 L_fin1
    buffer_load_dwordx4 v[156:159], v136, s[24:27], s48 offen nt
    buffer_load_dwordx4 v[160:163], v136, s[24:27], s48 offen offset:1024 nt
    buffer_load_dwordx4 v[164:167], v137, s[32:35], s97 offen nt
L_fin1:
    v_add_f32 v57, v57, v58
    v_mov_b32 v54, v57
    v_pk_mul_f32 v[44:45], v[12:13], v[58:59] op_sel:[0,1]
    v_pk_mul_f32 v[46:47], v[14:15], v[58:59] op_sel:[0,1]
    v_pk_mul_f32 v[48:49], v[16:17], v[58:59] op_sel:[0,1]
    v_pk_mul_f32 v[50:51], v[18:19], v[58:59] op_sel:[0,1]
    ds_write_b128 v152, v[44:47] offset:8192
    ds_write_b128 v152, v[48:51] offset:8208
    v_permlane16_swap_b32 v57, v54
    v_add_f32 v57, v57, v54
    v_mov_b32 v54, v57
    s_nop 1
    v_permlane32_swap_b32 v57, v54
    v_add_f32 v57, v57, v54
    v_mul_f32 v54, v57, v60
    ds_write_b32 v153, v54 offset:6336
    s_nop 0
L_fin2:
    s_cmp_ge_u32 s3, 4
    s_waitcnt lgkmcnt(0)
    s_barrier
    ds_read_b32 v56, v154
    s_cbranch_scc1 L_nopub
    ds_read_b64 v[20:21], v168 offset:8192
    ds_read_b64 v[22:23], v168 offset:10240
    ds_read_b64 v[24:25], v168 offset:12288
    ds_read_b64 v[26:27], v168 offset:14336
    ds_read_b64 v[28:29], v168 offset:16384
    ds_read_b64 v[30:31], v168 offset:18432
    ds_read_b64 v[32:33], v168 offset:20480
    ds_read_b64 v[34:35], v168 offset:22528
    ds_read_b128 v[248:251], v155 offset:6336
    ds_read_b128 v[252:255], v155 offset:6352
    s_mov_b32 vcc_lo, 0xaaaaaaaa
    s_mov_b32 vcc_hi, 0xaaaaaaaa
    s_waitcnt lgkmcnt(6)
    v_pk_add_f32 v[20:21], v[20:21], v[22:23]
    v_pk_add_f32 v[24:25], v[24:25], v[26:27]
    v_readfirstlane_b32 s7, v56
    s_waitcnt lgkmcnt(2)
    v_pk_add_f32 v[28:29], v[28:29], v[30:31]
    v_pk_add_f32 v[32:33], v[32:33], v[34:35]
    v_pk_add_f32 v[20:21], v[20:21], v[24:25]
    v_pk_add_f32 v[28:29], v[28:29], v[32:33]
    s_cmp_gt_u32 s7, s57
    s_waitcnt lgkmcnt(0)
    v_pk_add_f32 v[248:249], v[248:249], v[250:251]
    v_pk_add_f32 v[252:253], v[252:253], v[254:255]
    v_pk_add_f32 v[172:173], v[20:21], v[28:29]
    v_pk_add_f32 v[248:249], v[248:249], v[252:253]
    s_nop 1
    s_cbranch_scc1 L_redo
    v_add_f32 v174, v248, v249
    v_cndmask_b32 v174, v142, v174, vcc
    buffer_store_dwordx4 v[172:175], v138, s[64:67], s68 offen sc1
    s_cmp_eq_u32 s3, 0
    s_nop 0
    s_cbranch_scc0 L_wo
    s_branch L_wprep
L_nopub:
    s_waitcnt lgkmcnt(0)
    v_readfirstlane_b32 s7, v56
    s_nop 0
    s_cmp_gt_u32 s7, s57
    s_nop 2
    s_cbranch_scc1 L_redo
L_wo:
    buffer_load_dwordx4 v[156:159], v136, s[24:27], s48 offen nt
    buffer_load_dwordx4 v[160:163], v136, s[24:27], s48 offen offset:1024 nt
    buffer_load_dwordx4 v[164:167], v137, s[32:35], s97 offen nt
L_wprep:
    v_lshrrev_b32 v53, 4, v1
    v_lshlrev_b32 v53, 7, v53
    v_and_b32 v58, 7, v1
    v_lshl_add_u32 v53, v58, 4, v53
    s_lshl_b32 s51, s3, 9
    s_add_u32 s51, s51, s71
    s_add_u32 s47, s6, 0x5bd1e995
    v_lshrrev_b32 v52, 3, v1
    v_lshlrev_b32 v52, 2, v52
    v_mov_b32 v54, 0x07060501
    v_mov_b32 v55, 0x07060502
    v_mov_b32 v56, 0x07060503
    v_lshrrev_b32 v57, 5, v1
    v_lshlrev_b32 v57, 1, v57
    v_and_b32 v58, 7, v1
    v_lshl_add_u32 v57, v58, 2, v57
    v_mov_b32 v47, s47
    s_cmp_eq_u32 s3, 0
    s_nop 0
    s_cbranch_scc1 L_w_12
    s_waitcnt vmcnt(0)
L_w_12:
    s_waitcnt vmcnt(0)
    v_lshlrev_b32 v240, 16, v164
    v_and_b32 v241, 0xffff0000, v164
    v_lshlrev_b32 v242, 16, v165
    v_and_b32 v243, 0xffff0000, v165
    v_lshlrev_b32 v244, 16, v166
    v_and_b32 v245, 0xffff0000, v166
    v_lshlrev_b32 v246, 16, v167
    v_and_b32 v247, 0xffff0000, v167
    v_mul_f32 v240, v139, v240
    v_mul_f32 v241, v139, v241
    v_mul_f32 v242, v139, v242
    v_mul_f32 v243, v139, v243
    v_mul_f32 v244, v139, v244
    v_mul_f32 v245, v139, v245
    v_mul_f32 v246, v139, v246
    v_mul_f32 v247, v139, v247
    v_permlane32_swap_b32 v240, v241
    v_permlane32_swap_b32 v242, v243
    v_permlane32_swap_b32 v244, v245
    v_permlane32_swap_b32 v246, v247
    v_add_f32 v240, v240, v241
    v_add_f32 v242, v242, v243
    v_add_f32 v244, v244, v245
    v_add_f32 v246, v246, v247
    v_permlane16_swap_b32 v240, v242
    s_nop 0
    v_permlane16_swap_b32 v244, v246
    v_add_f32 v240, v240, v242
    v_add_f32 v244, v244, v246
    s_nop 0
    v_add_f32 v240, v240, v240 row_ror:8 row_mask:0xf bank_mask:0xf
    v_add_f32 v244, v244, v244 row_ror:8 row_mask:0xf bank_mask:0xf
    v_perm_b32 v232, v160, v156, v62
    v_perm_b32 v233, v160, v156, v63
    v_perm_b32 v234, v161, v157, v62
    v_perm_b32 v235, v161, v157, v63
    v_perm_b32 v236, v162, v158, v62
    v_perm_b32 v237, v162, v158, v63
    v_perm_b32 v238, v163, v159, v62
    v_perm_b32 v239, v163, v159, v63
    s_nop 1
    s_cbranch_scc0 L_barE
    buffer_load_dwordx4 v[216:219], v3, s[64:67], s71 offen offset:0 sc1
    buffer_load_dwordx4 v[220:223], v3, s[64:67], s71 offen offset:1024 sc1
    buffer_load_dwordx4 v[224:227], v3, s[64:67], s71 offen offset:2048 sc1
    buffer_load_dwordx4 v[228:231], v3, s[64:67], s71 offen offset:3072 sc1
    s_mov_b32 s49, 400000
L_p1:
    s_waitcnt vmcnt(0)
    v_xor_b32 v38, s6, v219
    v_xor_b32 v39, s6, v223
    v_or_b32 v38, v38, v39
    v_xor_b32 v39, s6, v227
    v_xor_b32 v37, s6, v231
    v_or3_b32 v38, v38, v39, v37
    v_cmp_ne_u32 vcc, 0, v38
    s_sub_u32 s49, s49, 1
    s_cbranch_scc1 L_p1d
    s_and_b64 exec, exec, vcc
    s_nop 1
    s_cbranch_execz L_p1d
    s_sleep 1
    buffer_load_dwordx4 v[216:219], v3, s[64:67], s71 offen offset:0 sc1
    buffer_load_dwordx4 v[220:223], v3, s[64:67], s71 offen offset:1024 sc1
    buffer_load_dwordx4 v[224:227], v3, s[64:67], s71 offen offset:2048 sc1
    buffer_load_dwordx4 v[228:231], v3, s[64:67], s71 offen offset:3072 sc1
    s_branch L_p1
L_p1d:
    s_mov_b64 exec, -1
    v_max3_f32 v28, v218, v222, v226
    v_max_f32 v28, v28, v230
    s_nop 1
    v_max_f32 v28, v28, v28 row_ror:8 row_mask:0xf bank_mask:0xf
    v_mov_b32 v29, v28
    s_nop 1
    v_permlane16_swap_b32 v28, v29
    v_max_f32 v28, v28, v29
    v_mov_b32 v29, v28
    s_nop 1
    v_permlane32_swap_b32 v28, v29
    v_max_f32 v28, v28, v29
    v_mul_f32 v28, s69, v28
    v_fma_f32 v20, v218, s69, -v28
    v_fma_f32 v21, v222, s69, -v28
    v_fma_f32 v22, v226, s69, -v28
    v_fma_f32 v23, v230, s69, -v28
    v_exp_f32 v20, v20
    v_exp_f32 v21, v21
    v_exp_f32 v22, v22
    v_exp_f32 v23, v23
    v_mul_f32 v30, v20, v216 quad_perm:[0,0,2,2] row_mask:0xf bank_mask:0xf
    v_mul_f32 v31, v20, v217 quad_perm:[0,0,2,2] row_mask:0xf bank_mask:0xf
    v_mul_f32 v32, v20, v218 quad_perm:[0,0,2,2] row_mask:0xf bank_mask:0xf
    v_fmac_f32 v30, v21, v220 quad_perm:[0,0,2,2] row_mask:0xf bank_mask:0xf
    v_fmac_f32 v31, v21, v221 quad_perm:[0,0,2,2] row_mask:0xf bank_mask:0xf
    v_fmac_f32 v32, v21, v222 quad_perm:[0,0,2,2] row_mask:0xf bank_mask:0xf
    v_fmac_f32 v30, v22, v224 quad_perm:[0,0,2,2] row_mask:0xf bank_mask:0xf
    v_fmac_f32 v31, v22, v225 quad_perm:[0,0,2,2] row_mask:0xf bank_mask:0xf
    v_fmac_f32 v32, v22, v226 quad_perm:[0,0,2,2] row_mask:0xf bank_mask:0xf
    v_fmac_f32 v30, v23, v228 quad_perm:[0,0,2,2] row_mask:0xf bank_mask:0xf
    v_fmac_f32 v31, v23, v229 quad_perm:[0,0,2,2] row_mask:0xf bank_mask:0xf
    v_fmac_f32 v32, v23, v230 quad_perm:[0,0,2,2] row_mask:0xf bank_mask:0xf
    v_mov_b32 v33, v32
    v_permlane32_swap_b32 v30, v31
    s_nop 0
    v_permlane32_swap_b32 v32, v33
    v_add_f32 v30, v30, v31
    v_add_f32 v32, v32, v33
    s_nop 1
    v_permlane16_swap_b32 v30, v32
    v_add_f32 v30, v30, v32
    s_nop 1
    v_add_f32 v30, v30, v30 row_ror:8 row_mask:0xf bank_mask:0xf
    v_mov_b32 v32, v30
    s_nop 1
    v_permlane16_swap_b32 v30, v32
    s_nop 1
    v_rcp_f32 v28, v32 quad_perm:[1,1,3,3] row_mask:0xf bank_mask:0xf
    v_mov_b32 v31, v32 quad_perm:[1,1,3,3] row_mask:0xf bank_mask:0xf
    v_mul_f32 v33, v30, v28
    v_fma_f32 v34, -v33, v31, v30
    v_fma_f32 v30, v34, v28, v33
    v_cvt_pk_bf16_f32 v30, v30, v30
    ds_write_b16 v57, v30 offset:6176
    s_waitcnt lgkmcnt(0)
L_barE:
    s_barrier
    ds_read_b32 v30, v52 offset:6176
    s_mov_b32 s40, 0x00ff00ff
    s_mov_b32 s41, 0x00ff00ff
    s_waitcnt lgkmcnt(0)
    v_dot2_f32_bf16 v12, v232, v30, 0
    v_dot2_f32_bf16 v13, v233, v30, 0
    v_dot2_f32_bf16 v14, v234, v30, 0
    v_dot2_f32_bf16 v15, v235, v30, 0
    v_dot2_f32_bf16 v16, v236, v30, 0
    v_dot2_f32_bf16 v17, v237, v30, 0
    v_dot2_f32_bf16 v18, v238, v30, 0
    v_dot2_f32_bf16 v19, v239, v30, 0
    v_permlane32_swap_b32 v12, v13
    v_permlane32_swap_b32 v14, v15
    v_permlane32_swap_b32 v16, v17
    v_permlane32_swap_b32 v18, v19
    v_add_f32 v12, v12, v13
    v_add_f32 v14, v14, v15
    v_add_f32 v16, v16, v17
    v_add_f32 v18, v18, v19
    v_permlane16_swap_b32 v12, v14
    s_nop 0
    v_permlane16_swap_b32 v16, v18
    v_add_f32 v12, v12, v14
    v_add_f32 v16, v16, v18
    s_nop 0
    v_add_f32 v12, v12, v12 row_ror:8 row_mask:0xf bank_mask:0xf
    v_add_f32 v16, v16, v16 row_ror:8 row_mask:0xf bank_mask:0xf
    v_perm_b32 v44, v12, v16, v54
    v_perm_b32 v45, v240, v16, v55
    v_perm_b32 v46, v244, v16, v56
    s_mov_b64 exec, s[40:41]
    buffer_store_dwordx4 v[44:47], v53, s[64:67], s51 offen sc1
    s_mov_b64 exec, -1
    s_cmp_lt_u32 s100, 64
    s_cbranch_scc0 L_end
    s_cmp_ge_u32 s3, 4
    s_cbranch_scc0 L_end
    v_and_b32 v249, 7, v1
    v_lshlrev_b32 v249, 3, v249
    s_lshr_b32 s51, s100, 3
    s_lshl_b32 s51, s51, 7
    s_and_b32 s7, s100, 1
    s_lshl_b32 s7, s7, 6
    s_add_u32 s51, s51, s7
    s_bfe_u32 s7, s100, 0x10002
    s_lshl_b32 s7, s7, 1
    s_add_u32 s51, s51, s7
    s_bfe_u32 s7, s100, 0x10001
    s_lshl_b32 s7, s7, 2
    s_add_u32 s51, s51, s7
    buffer_load_ushort v248, v249, s[8:11], s51 offen
    v_lshrrev_b32 v53, 2, v1
    v_mul_u32_u24 v53, 4224, v53
    v_and_b32 v58, 3, v1
    v_lshl_add_u32 v53, v58, 4, v53
    s_sub_u32 s7, s3, 4
    s_mul_i32 s7, s7, 270336
    s_lshl_b32 s52, s100, 6
    s_add_u32 s52, s52, s7
    s_add_u32 s52, s52, 2097152
    s_add_u32 s53, s52, 67584
    s_add_u32 s54, s52, 135168
    s_add_u32 s55, s52, 202752
    v_mov_b32 v30, 0x04000c0c
    v_mov_b32 v31, 0x0706000c
    v_and_b32 v28, 3, v1
    v_lshlrev_b32 v28, 6, v28
    v_and_b32 v29, 0x30, v1
    v_add_u32 v28, v28, v29
    s_sub_u32 s7, s3, 4
    s_lshl_b32 s7, s7, 2
    v_add_u32 v28, s7, v28
    v_and_b32 v29, 7, v1
    v_lshlrev_b32 v29, 5, v29
    v_mov_b32 v41, s6
    v_mov_b32 v42, 0
    s_cmp_eq_u32 s100, 0
    s_cselect_b32 s46, 0, 1073741824
    s_waitcnt vmcnt(0)
    buffer_load_dwordx4 v[216:219], v53, s[64:67], s52 offen sc1
    buffer_load_dwordx4 v[220:223], v53, s[64:67], s53 offen sc1
    buffer_load_dwordx4 v[224:227], v53, s[64:67], s54 offen sc1
    buffer_load_dwordx4 v[228:231], v53, s[64:67], s55 offen sc1
    s_mov_b32 s49, 400000
L_p2:
    s_waitcnt vmcnt(0)
    v_xor_b32 v38, s47, v219
    v_xor_b32 v39, s47, v223
    v_or_b32 v38, v38, v39
    v_xor_b32 v39, s47, v227
    v_xor_b32 v37, s47, v231
    v_or3_b32 v38, v38, v39, v37
    v_cmp_ne_u32 vcc, 0, v38
    s_sub_u32 s49, s49, 1
    s_cbranch_scc1 L_p2d
    s_and_b64 exec, exec, vcc
    s_nop 1
    s_cbranch_execz L_p2d
    s_sleep 1
    buffer_load_dwordx4 v[216:219], v53, s[64:67], s52 offen sc1
    buffer_load_dwordx4 v[220:223], v53, s[64:67], s53 offen sc1
    buffer_load_dwordx4 v[224:227], v53, s[64:67], s54 offen sc1
    buffer_load_dwordx4 v[228:231], v53, s[64:67], s55 offen sc1
    s_branch L_p2
L_p2d:
    s_mov_b64 exec, -1
    v_perm_b32 v219, v218, v217, v30
    v_perm_b32 v223, v222, v221, v30
    v_perm_b32 v227, v226, v225, v30
    v_perm_b32 v231, v230, v229, v30
    v_perm_b32 v219, v219, v216, v31
    v_perm_b32 v223, v223, v220, v31
    v_perm_b32 v227, v227, v224, v31
    v_perm_b32 v231, v231, v228, v31
    v_pk_add_f32 v[216:217], v[216:217], v[220:221]
    v_pk_add_f32 v[224:225], v[224:225], v[228:229]
    v_pk_add_f32 v[218:219], v[218:219], v[222:223]
    v_pk_add_f32 v[226:227], v[226:227], v[230:231]
    v_pk_add_f32 v[216:217], v[216:217], v[224:225]
    v_pk_add_f32 v[218:219], v[218:219], v[226:227]
    s_nop 1
    v_permlane32_swap_b32 v216, v219
    v_permlane32_swap_b32 v217, v218
    v_add_f32 v216, v216, v219
    v_add_f32 v217, v217, v218
    s_nop 1
    v_permlane16_swap_b32 v216, v217
    v_add_f32 v216, v216, v217
    s_nop 1
    v_add_f32 v216, v216, v216 row_ror:4 row_mask:0xf bank_mask:0xf
    s_nop 1
    v_add_f32 v216, v216, v216 row_ror:8 row_mask:0xf bank_mask:0xf
    ds_write_b32 v28, v216 offset:6464
    s_cmp_eq_u32 s3, 4
    s_waitcnt lgkmcnt(0)
    s_barrier
    s_cbranch_scc0 L_end
    ds_read_b128 v[24:27], v29 offset:6480
    ds_read_b128 v[20:23], v29 offset:6464
    v_lshlrev_b32 v40, 16, v248
    s_waitcnt lgkmcnt(1)
    v_pk_add_f32 v[24:25], v[24:25], v[26:27]
    v_add_f32 v24, v24, v25
    s_waitcnt lgkmcnt(0)
    v_pk_add_f32 v[20:21], v[20:21], v[22:23]
    v_add_f32 v20, v20, v21
    v_cvt_pk_bf16_f32 v24, v24, v24
    v_and_b32 v24, 0xffff0000, v24
    v_cvt_pk_bf16_f32 v20, v20, v20
    v_and_b32 v20, 0xffff0000, v20
    v_mul_f32 v25, 0xbfb8aa3b, v24
    v_exp_f32 v25, v25
    s_nop 0
    v_add_f32 v25, 1.0, v25
    v_rcp_f32 v26, v25
    s_nop 0
    v_mul_f32 v28, v24, v26
    v_fma_f32 v27, -v28, v25, v24
    v_fma_f32 v27, v27, v26, v28
    v_cmp_o_f32 vcc, v27, v27
    s_nop 1
    v_cndmask_b32 v27, v28, v27, vcc
    v_cvt_pk_bf16_f32 v27, v27, v27
    v_and_b32 v27, 0xffff0000, v27
    v_mul_f32 v20, v20, v27
    v_cvt_pk_bf16_f32 v20, v20, v20
    v_and_b32 v20, 0xffff0000, v20
    v_add_f32 v20, v40, v20
    v_cvt_pk_bf16_f32 v20, v20, v20
    s_mov_b64 exec, 0xff
    buffer_store_short v20, v249, s[60:63], s51 offen
    s_mov_b64 exec, 1
    buffer_store_dword v41, v42, s[64:67], s46 offen
L_end:
    s_endpgm
L_slow:
    v_max3_f32 v38, v52, v54, v55
    v_mov_b32 v39, v38
    s_nop 1
    v_permlane16_swap_b32 v38, v39
    v_max_f32 v38, v38, v39
    v_mov_b32 v39, v38
    s_nop 1
    v_permlane32_swap_b32 v38, v39
    v_max_f32 v38, v38, v39
    v_sub_f32 v39, v52, v38
    v_mul_f32 v39, s69, v39
    v_exp_f32 v39, v39
    v_mov_b32 v52, v38
    v_mul_f32 v53, s69, v52
    v_and_b32 v40, 0x30, v1
    ds_bpermute_b32 v41, v40, v39
    v_bfe_u32 v42, v1, 2, 2
    v_lshlrev_b32 v42, 5, v42
    s_lshl_b32 s7, s3, 2
    v_add_u32 v43, s7, v42
    ds_write_b32 v43, v52 offset:6208
    v_mov_b32 v42, 6160
    v_mov_b32 v43, 1
    ds_write_b32 v42, v43
    v_mul_f32 v57, v57, v39
    v_mul_f32 v58, v58, v39
    s_waitcnt lgkmcnt(0)
    v_mul_f32 v12, v12, v41
    v_mul_f32 v13, v13, v41
    v_mul_f32 v14, v14, v41
    v_mul_f32 v15, v15, v41
    v_mul_f32 v16, v16, v41
    v_mul_f32 v17, v17, v41
    v_mul_f32 v18, v18, v41
    v_mul_f32 v19, v19, v41
    v_fma_f32 v36, v54, s69, -v53
    v_fma_f32 v37, v55, s69, -v53
    s_cmp_eq_u32 s51, 0
    s_nop 0
    s_cbranch_scc1 L_slowr0
    s_branch L_slowr1
L_redo:
    s_mov_b32 s57, 1
    v_bfe_u32 v140, v1, 2, 2
    v_lshlrev_b32 v140, 5, v140
    s_lshl_b32 s7, s3, 2
    v_add_u32 v141, s7, v140
    ds_read_b128 v[144:147], v140 offset:6208
    ds_read_b128 v[148:151], v140 offset:6224
    v_and_b32 v141, 0x30, v1
    s_and_b32 s7, s3, 3
    s_lshl_b32 s7, s7, 2
    s_waitcnt lgkmcnt(0)
    v_max3_f32 v144, v144, v145, v146
    v_max3_f32 v148, v148, v149, v150
    v_max3_f32 v144, v144, v147, v151
    v_max_f32 v144, v144, v148
    v_sub_f32 v60, v52, v144
    v_mul_f32 v60, s69, v60
    v_exp_f32 v60, v60
    v_readlane_b32 s7, v144, s7
    s_nop 0
    ds_bpermute_b32 v59, v141, v60
    v_mov_b32 v142, s7
    s_waitcnt lgkmcnt(0)
    s_nop 0
    s_barrier
    v_pk_mul_f32 v[44:45], v[12:13], v[58:59] op_sel:[0,1]
    v_pk_mul_f32 v[46:47], v[14:15], v[58:59] op_sel:[0,1]
    v_pk_mul_f32 v[48:49], v[16:17], v[58:59] op_sel:[0,1]
    v_pk_mul_f32 v[50:51], v[18:19], v[58:59] op_sel:[0,1]
    ds_write_b128 v152, v[44:47] offset:8192
    ds_write_b128 v152, v[48:51] offset:8208
    v_mul_f32 v54, v57, v60
    ds_write_b32 v153, v54 offset:6336
    s_nop 0
    s_branch L_fin2
.section .rodata,"a"
.p2align 6
.amdhsa_kernel recurrent_scan__gqa_block_cached__glu_gated_geglu__decode_kernel
  .amdhsa_next_free_vgpr 256
  .amdhsa_next_free_sgpr 102
  .amdhsa_accum_offset 256
  .amdhsa_group_segment_fixed_size 0
  .amdhsa_kernarg_size 96
  .amdhsa_user_sgpr_count 2
  .amdhsa_user_sgpr_kernarg_segment_ptr 1
  .amdhsa_system_sgpr_workgroup_id_x 1
.end_amdhsa_kernel
```
